```python
import torch

def _softmax(x, axis=-1):
    return torch.softmax(x, dim=axis)
def _gelu(x):
    return torch.nn.functional.gelu(x, approximate="tanh")
def _silu(x):
    return torch.nn.functional.silu(x)
def _sigmoid(x):
    return torch.sigmoid(x)
def _layernorm(x, axis=-1, eps=1e-5):
    m = x.mean(dim=axis, keepdim=True)
    v = x.var(dim=axis, keepdim=True, unbiased=False)
    return (x - m) / torch.sqrt(v + eps)
def _scatter_add(tgt, idx, src, axis=0):
    return tgt.clone().index_add_(axis, idx, src)
def _segment_sum(src, seg, n):
    out = torch.zeros((n,) + src.shape[1:], dtype=src.dtype)
    return out.index_add_(0, seg, src)
def _pad(x, pw):
    flat = tuple(v for pair in reversed(pw) for v in pair)
    return torch.nn.functional.pad(x, flat)

kernel_name = 'standalone__weight_only_int_quip__prompt'

def setup_inputs():

    _w = (lambda a: (lambda t: t.to(torch.bfloat16) if t.is_floating_point() else t)(torch.as_tensor(a)))
    B, S, D, F = 1, 2048, 640, 1536
    G = 128 if 128 > 0 else D
    D = (D // G) * G
    ng = D // G
    bits = 4 if 4 > 0 else 4
    qmax = 1 << bits
    qw = torch.randint(0, qmax, (D, F)).to(torch.int32)
    U, _ = (lambda *_a, **_k: torch.linalg.qr(*[torch.as_tensor(_x).float() for _x in _a], **_k))((lambda *s: torch.randn(*s, dtype=torch.bfloat16) * 0.05)(D, D))
    V, _ = (lambda *_a, **_k: torch.linalg.qr(*[torch.as_tensor(_x).float() for _x in _a], **_k))((lambda *s: torch.randn(*s, dtype=torch.bfloat16) * 0.05)(F, F))
    return {
        "x": _w((lambda *s: torch.randn(*s, dtype=torch.bfloat16) * 0.05)(B, S, D)),
        "qw": _w(qw),
        "scales": _w(torch.abs((lambda *s: torch.randn(*s, dtype=torch.bfloat16) * 0.05)(ng, F)) * 0.02 + 0.005),
        "zeros": _w(torch.full((ng, F), qmax / 2.0, dtype=float)),
        "U": _w(U.to(float)),
        "V": _w(V.to(float)),
    }

def reference(x, qw, scales, zeros, U, V):
    B, S, D = x.shape
    ng, F = scales.shape
    G = D // ng
    s = (lambda x, n, axis: torch.repeat_interleave(x, n, dim=axis))(scales, G, axis=0)
    z = (lambda x, n, axis: torch.repeat_interleave(x, n, dim=axis))(zeros, G, axis=0)
    wq = ((lambda x, dt: x.to(dt))(qw, x.dtype) - z) * s
    xr = torch.einsum("bsd,de->bse", x, U)
    h  = torch.einsum("bse,ef->bsf", xr, wq)
    y  = torch.einsum("bsf,fg->bsg", h, V)
    return y
```

```asm
; @launch grid=(256,1,1) block=(256,1,1) lds=163840
.amdgcn_target "amdgcn-amd-amdhsa--gfx950"
.text
.globl standalone__weight_only_int_quip__prompt_kernel
.p2align 8
.type standalone__weight_only_int_quip__prompt_kernel,@function
standalone__weight_only_int_quip__prompt_kernel:
    s_cmp_ge_u32 s2, 256
    s_cbranch_scc1 L_end
    s_load_dwordx16 s[4:19], s[0:1], 0
    s_load_dwordx2 s[20:21], s[0:1], 64
    v_lshrrev_b32 v2, 6, v0
    v_and_b32 v1, 63, v0
    s_and_b32 s45, s2, 7
    v_readfirstlane_b32 s44, v2
    s_lshr_b32 s46, s2, 3
    v_lshlrev_b32 v10, 4, v1
    s_cmp_ge_u32 s46, 24
    s_cbranch_scc1 L_x
    s_mul_i32 s50, s46, 43
    s_lshr_b32 s50, s50, 8
    s_mul_i32 s51, s50, 6
    s_sub_u32 s51, s46, s51
    s_lshr_b32 s52, s45, 2
    s_lshl_b32 s47, s52, 2
    s_add_u32 s47, s47, s50
    s_and_b32 s48, s45, 3
    s_mul_i32 s48, s48, 6
    s_add_u32 s48, s48, s51
    s_mov_b32 s51, 0
    s_mul_i32 s91, s50, 3
    s_add_u32 s91, s91, s51
    s_add_u32 s91, s91, s52
    s_cmp_ge_u32 s91, 12
    s_cselect_b32 s51, 12, 0
    s_sub_u32 s91, s91, s51
    v_lshrrev_b32 v2, 4, v1
    s_mul_i32 s50, s44, 20
    v_add_u32 v2, s50, v2
    v_and_b32 v3, 15, v1
    s_movk_i32 s53, 6144
    v_add_u32 v4, 0, v2
    v_and_b32 v5, 15, v4
    v_xor_b32 v5, v5, v3
    v_mul_u32_u24 v4, s53, v4
    v_lshl_add_u32 v152, v5, 4, v4
    v_add_u32 v4, 4, v2
    v_and_b32 v5, 15, v4
    v_xor_b32 v5, v5, v3
    v_mul_u32_u24 v4, s53, v4
    v_lshl_add_u32 v153, v5, 4, v4
    v_subrev_u32 v153, 1024, v153
    v_add_u32 v4, 8, v2
    v_and_b32 v5, 15, v4
    v_xor_b32 v5, v5, v3
    v_mul_u32_u24 v4, s53, v4
    v_lshl_add_u32 v154, v5, 4, v4
    v_subrev_u32 v154, 2048, v154
    v_add_u32 v4, 12, v2
    v_and_b32 v5, 15, v4
    v_xor_b32 v5, v5, v3
    v_mul_u32_u24 v4, s53, v4
    v_lshl_add_u32 v155, v5, 4, v4
    v_subrev_u32 v155, 3072, v155
    v_add_u32 v4, 16, v2
    v_and_b32 v5, 15, v4
    v_xor_b32 v5, v5, v3
    v_mul_u32_u24 v4, s53, v4
    v_lshl_add_u32 v156, v5, 4, v4
    s_mul_i32 s51, s47, 491520
    s_lshl_b32 s52, s48, 8
    s_add_u32 s92, s51, s52
    s_mul_i32 s57, s44, 40960
    s_add_u32 m0, s57, 32768
    v_and_b32 v157, 48, v1
    s_and_b32 s52, s44, 1
    s_lshl_b32 s52, s52, 6
    s_lshl_b32 s53, s48, 7
    s_add_u32 s52, s52, s53
    s_lshr_b32 s53, s44, 1
    s_add_u32 s53, s53, 0
    s_min_u32 s53, s53, 4
    s_mul_i32 s54, s47, 5
    s_add_u32 s53, s53, s54
    s_lshr_b32 s53, s53, 3
    s_mul_i32 s53, s53, 3072
    s_add_u32 s93, s53, s52
    s_lshr_b32 s53, s44, 1
    s_add_u32 s53, s53, 2
    s_min_u32 s53, s53, 4
    s_mul_i32 s54, s47, 5
    s_add_u32 s53, s53, s54
    s_lshr_b32 s53, s53, 3
    s_mul_i32 s53, s53, 3072
    s_add_u32 s94, s53, s52
    s_lshr_b32 s53, s44, 1
    s_add_u32 s53, s53, 4
    s_min_u32 s53, s53, 4
    s_mul_i32 s54, s47, 5
    s_add_u32 s53, s53, s54
    s_lshr_b32 s53, s53, 3
    s_mul_i32 s53, s53, 3072
    s_add_u32 s95, s53, s52
    s_waitcnt lgkmcnt(0)
    s_mov_b32 s28, s6
    s_and_b32 s29, s7, 0xffff
    s_mov_b32 s30, 0x3c0000
    s_mov_b32 s31, 0x20000
    buffer_load_dwordx4 v152, s[28:31], s92 offen offset:0 lds
    buffer_load_dwordx4 v153, s[28:31], s92 offen offset:1024 lds
    buffer_load_dwordx4 v154, s[28:31], s92 offen offset:2048 lds
    buffer_load_dwordx4 v155, s[28:31], s92 offen offset:3072 lds
    s_add_u32 m0, s57, 36864
    s_nop 0
    buffer_load_dwordx4 v156, s[28:31], s92 offen offset:0 lds
    s_mov_b32 s36, s8
    s_and_b32 s37, s9, 0xffff
    s_mov_b32 s38, 0x3c00
    s_mov_b32 s39, 0x20000
    s_mov_b32 s40, s10
    s_and_b32 s41, s11, 0xffff
    s_mov_b32 s42, 0x3c00
    s_mov_b32 s43, 0x20000
    buffer_load_dwordx4 v[128:131], v157, s[36:39], s93 offen
    buffer_load_dwordx4 v[132:135], v157, s[40:43], s93 offen
    buffer_load_dwordx4 v[136:139], v157, s[36:39], s94 offen
    buffer_load_dwordx4 v[140:143], v157, s[40:43], s94 offen
    buffer_load_dwordx4 v[144:147], v157, s[36:39], s95 offen
    buffer_load_dwordx4 v[148:151], v157, s[40:43], s95 offen
    s_mov_b32 s24, s20
    s_and_b32 s25, s21, 0xffff
    s_mov_b32 s26, 0x800000
    s_mov_b32 s27, 0x20000
    s_add_u32 s22, s20, 0x700000
    s_addc_u32 s23, s21, 0
    s_load_dword s80, s[22:23], 0
    s_mov_b32 s32, s14
    s_and_b32 s33, s15, 0xffff
    s_mov_b32 s34, 0x480000
    s_mov_b32 s35, 0x20000
    v_lshrrev_b32 v6, 3, v1
    v_and_b32 v7, 7, v1
    v_lshrrev_b32 v8, 2, v1
    v_and_b32 v8, 4, v8
    v_xor_b32 v7, v7, v8
    s_movk_i32 s50, 3072
    v_mul_u32_u24 v6, s50, v6
    v_lshl_add_u32 v2, v7, 4, v6
    v_add_u32 v3, 23552, v2
    v_add_u32 v4, 47104, v2
    v_add_u32 v5, 70656, v2
    v_lshrrev_b32 v11, 4, v1
    v_lshlrev_b32 v11, 3, v11
    v_bfe_u32 v12, v1, 2, 2
    v_add_u32 v11, v11, v12
    v_lshlrev_b32 v11, 7, v11
    v_and_b32 v12, 3, v1
    v_lshrrev_b32 v13, 1, v1
    v_and_b32 v13, 4, v13
    v_xor_b32 v12, v12, v13
    v_lshl_add_u32 v11, v12, 4, v11
    s_mov_b32 s53, s57
    s_add_u32 s50, s44, 0
    s_and_b32 s51, s50, 1
    s_lshl_b32 s51, s51, 3
    s_add_u32 s51, s51, s53
    s_and_b32 s50, s50, 2
    s_lshl_b32 s50, s50, 5
    v_xor_b32 v6, s50, v11
    v_add_u32 v6, s51, v6
    s_add_u32 s50, s44, 1
    s_and_b32 s51, s50, 1
    s_lshl_b32 s51, s51, 3
    s_add_u32 s51, s51, s53
    s_and_b32 s50, s50, 2
    s_lshl_b32 s50, s50, 5
    v_xor_b32 v7, s50, v11
    v_add_u32 v7, s51, v7
    s_add_u32 s50, s44, 2
    s_and_b32 s51, s50, 1
    s_lshl_b32 s51, s51, 3
    s_add_u32 s51, s51, s53
    s_and_b32 s50, s50, 2
    s_lshl_b32 s50, s50, 5
    v_xor_b32 v8, s50, v11
    v_add_u32 v8, s51, v8
    s_add_u32 s50, s44, 3
    s_and_b32 s51, s50, 1
    s_lshl_b32 s51, s51, 3
    s_add_u32 s51, s51, s53
    s_and_b32 s50, s50, 2
    s_lshl_b32 s50, s50, 5
    v_xor_b32 v9, s50, v11
    v_add_u32 v9, s51, v9
    s_mul_i32 s55, s44, 1179648
    s_lshl_b32 s50, s48, 7
    s_add_u32 s55, s55, s50
    s_mul_i32 s56, s47, 245760
    s_mul_i32 s50, s44, 12288
    s_add_u32 s56, s56, s50
    s_add_u32 s56, s56, 0
    s_mov_b32 s50, s91
    s_mul_i32 s86, s50, 98304
    s_add_u32 s86, s86, s55
    s_add_u32 s87, s55, 1179648
    s_lshl_b32 s88, s50, 10
    s_add_u32 s88, s88, s56
    s_add_u32 s90, s56, 12288
    s_add_u32 m0, s57, 0
    s_nop 0
    buffer_load_dwordx4 v2, s[32:35], s86 offen offset:0 lds
    buffer_load_dwordx4 v3, s[32:35], s86 offen offset:1024 lds
    buffer_load_dwordx4 v4, s[32:35], s86 offen offset:2048 lds
    buffer_load_dwordx4 v5, s[32:35], s86 offen offset:3072 lds
    s_lshr_b32 s81, s45, 1
    s_lshl_b32 s81, s81, 2
    s_lshr_b32 s50, s46, 3
    s_add_u32 s81, s81, s50
    s_and_b32 s49, s45, 1
    s_lshl_b32 s49, s49, 3
    s_and_b32 s50, s46, 7
    s_add_u32 s49, s49, s50
    s_lshl_b32 s60, s81, 9
    s_add_u32 s60, s60, 0x718000
    s_mul_i32 s61, s49, 3
    s_lshr_b32 s61, s61, 1
    s_lshl_b32 s61, s61, 10
    s_add_u32 s61, s61, 0x710000
    v_and_b32 v11, 15, v1
    v_lshrrev_b32 v12, 4, v1
    v_lshlrev_b32 v12, 1, v12
    s_and_b32 s50, s44, 1
    s_lshl_b32 s50, s50, 3
    v_add_u32 v12, s50, v12
    v_xor_b32 v12, v12, v11
    s_lshr_b32 s50, s44, 1
    s_lshl_b32 s50, s50, 4
    v_add_u32 v11, s50, v11
    s_movk_i32 s51, 3277
    s_mov_b32 s52, 35840
    v_add_u32 v13, 0, v11
    v_min_u32 v13, 79, v13
    v_mul_u32_u24 v14, s51, v13
    v_lshrrev_b32 v14, 16, v14
    v_mul_u32_u24 v14, s52, v14
    v_lshl_add_u32 v13, v13, 8, v14
    v_add_u32 v13, 32768, v13
    v_lshl_add_u32 v152, v12, 4, v13
    v_xor_b32 v153, 16, v152
    v_add_u32 v13, 32, v11
    v_min_u32 v13, 79, v13
    v_mul_u32_u24 v14, s51, v13
    v_lshrrev_b32 v14, 16, v14
    v_mul_u32_u24 v14, s52, v14
    v_lshl_add_u32 v13, v13, 8, v14
    v_add_u32 v13, 32768, v13
    v_lshl_add_u32 v154, v12, 4, v13
    v_xor_b32 v155, 16, v154
    v_add_u32 v13, 64, v11
    v_min_u32 v13, 79, v13
    v_mul_u32_u24 v14, s51, v13
    v_lshrrev_b32 v14, 16, v14
    v_mul_u32_u24 v14, s52, v14
    v_lshl_add_u32 v13, v13, 8, v14
    v_add_u32 v13, 32768, v13
    v_lshl_add_u32 v156, v12, 4, v13
    v_xor_b32 v157, 16, v156
    s_mul_i32 s50, s47, 5
    s_lshr_b32 s51, s44, 1
    s_add_u32 s50, s50, s51
    s_mul_i32 s50, s50, 48
    s_lshl_b32 s51, s48, 1
    s_add_u32 s50, s50, s51
    s_and_b32 s51, s44, 1
    s_add_u32 s50, s50, s51
    s_lshl_b32 s50, s50, 10
    s_add_u32 s92, s50, 0
    s_add_u32 s93, s92, 98304
    s_add_u32 s94, s92, 196608
    s_mul_i32 s59, s47, 3072
    s_add_u32 s59, s59, 0x708000
    s_lshl_b32 s50, s48, 7
    s_add_u32 s58, s59, s50
    s_mul_i32 s50, s44, 768
    s_add_u32 s59, s59, s50
    s_lshl_b32 s89, s48, 10
    s_lshl_b32 s50, s47, 7
    s_add_u32 s89, s89, s50
    s_add_u32 s89, s89, 0x710000
    s_waitcnt lgkmcnt(0)
    s_mul_i32 s80, s80, 0x9E3779B1
    s_add_u32 s80, s80, 0x7F4A7C15
    s_xor_b32 s62, s80, 0x5bd1e995
    s_mul_i32 s62, s62, 0x85EBCA6B
    s_waitcnt vmcnt(4)
    v_lshlrev_b32 v48, 16, v128
    v_and_b32 v49, 0xffff0000, v128
    v_lshlrev_b32 v56, 16, v132
    v_and_b32 v57, 0xffff0000, v132
    v_lshlrev_b32 v50, 16, v129
    v_and_b32 v51, 0xffff0000, v129
    v_lshlrev_b32 v58, 16, v133
    v_and_b32 v59, 0xffff0000, v133
    v_lshlrev_b32 v52, 16, v130
    v_and_b32 v53, 0xffff0000, v130
    v_lshlrev_b32 v60, 16, v134
    v_and_b32 v61, 0xffff0000, v134
    v_lshlrev_b32 v54, 16, v131
    v_and_b32 v55, 0xffff0000, v131
    v_lshlrev_b32 v62, 16, v135
    v_and_b32 v63, 0xffff0000, v135
    v_pk_mul_f32 v[56:57], v[56:57], v[48:49] neg_lo:[1,0] neg_hi:[1,0]
    v_pk_mul_f32 v[58:59], v[58:59], v[50:51] neg_lo:[1,0] neg_hi:[1,0]
    v_pk_mul_f32 v[60:61], v[60:61], v[52:53] neg_lo:[1,0] neg_hi:[1,0]
    v_pk_mul_f32 v[62:63], v[62:63], v[54:55] neg_lo:[1,0] neg_hi:[1,0]
    s_barrier
    ds_read_b128 v[16:19], v152
    ds_read_b128 v[20:23], v153
    ds_read_b128 v[24:27], v154
    ds_read_b128 v[28:31], v155
    ds_read_b128 v[32:35], v156
    ds_read_b128 v[36:39], v157
    s_waitcnt lgkmcnt(4)
    v_cvt_f32_i32 v16, v16
    v_cvt_f32_i32 v17, v17
    v_cvt_f32_i32 v18, v18
    v_cvt_f32_i32 v19, v19
    v_cvt_f32_i32 v20, v20
    v_cvt_f32_i32 v21, v21
    v_cvt_f32_i32 v22, v22
    v_cvt_f32_i32 v23, v23
    v_pk_fma_f32 v[16:17], v[16:17], v[48:49], v[56:57]
    v_pk_fma_f32 v[18:19], v[18:19], v[50:51], v[58:59]
    v_pk_fma_f32 v[20:21], v[20:21], v[52:53], v[60:61]
    v_pk_fma_f32 v[22:23], v[22:23], v[54:55], v[62:63]
    v_cvt_pk_bf16_f32 v100, v16, v17
    v_cvt_pk_bf16_f32 v101, v18, v19
    v_cvt_pk_bf16_f32 v102, v20, v21
    v_cvt_pk_bf16_f32 v103, v22, v23
    buffer_store_dwordx4 v[100:103], v10, s[24:27], s92 offen sc1
    v_lshlrev_b32 v64, 16, v136
    v_and_b32 v65, 0xffff0000, v136
    v_lshlrev_b32 v72, 16, v140
    v_and_b32 v73, 0xffff0000, v140
    v_lshlrev_b32 v66, 16, v137
    v_and_b32 v67, 0xffff0000, v137
    v_lshlrev_b32 v74, 16, v141
    v_and_b32 v75, 0xffff0000, v141
    v_lshlrev_b32 v68, 16, v138
    v_and_b32 v69, 0xffff0000, v138
    v_lshlrev_b32 v76, 16, v142
    v_and_b32 v77, 0xffff0000, v142
    v_lshlrev_b32 v70, 16, v139
    v_and_b32 v71, 0xffff0000, v139
    v_lshlrev_b32 v78, 16, v143
    v_and_b32 v79, 0xffff0000, v143
    v_pk_mul_f32 v[72:73], v[72:73], v[64:65] neg_lo:[1,0] neg_hi:[1,0]
    v_pk_mul_f32 v[74:75], v[74:75], v[66:67] neg_lo:[1,0] neg_hi:[1,0]
    v_pk_mul_f32 v[76:77], v[76:77], v[68:69] neg_lo:[1,0] neg_hi:[1,0]
    v_pk_mul_f32 v[78:79], v[78:79], v[70:71] neg_lo:[1,0] neg_hi:[1,0]
    s_waitcnt lgkmcnt(2)
    v_cvt_f32_i32 v24, v24
    v_cvt_f32_i32 v25, v25
    v_cvt_f32_i32 v26, v26
    v_cvt_f32_i32 v27, v27
    v_cvt_f32_i32 v28, v28
    v_cvt_f32_i32 v29, v29
    v_cvt_f32_i32 v30, v30
    v_cvt_f32_i32 v31, v31
    v_pk_fma_f32 v[24:25], v[24:25], v[64:65], v[72:73]
    v_pk_fma_f32 v[26:27], v[26:27], v[66:67], v[74:75]
    v_pk_fma_f32 v[28:29], v[28:29], v[68:69], v[76:77]
    v_pk_fma_f32 v[30:31], v[30:31], v[70:71], v[78:79]
    v_cvt_pk_bf16_f32 v104, v24, v25
    v_cvt_pk_bf16_f32 v105, v26, v27
    v_cvt_pk_bf16_f32 v106, v28, v29
    v_cvt_pk_bf16_f32 v107, v30, v31
    buffer_store_dwordx4 v[104:107], v10, s[24:27], s93 offen sc1
    s_waitcnt lgkmcnt(0)
    s_cmp_ge_u32 s44, 2
    s_cbranch_scc1 L_dskip_1
    v_lshlrev_b32 v80, 16, v144
    v_and_b32 v81, 0xffff0000, v144
    v_lshlrev_b32 v88, 16, v148
    v_and_b32 v89, 0xffff0000, v148
    v_lshlrev_b32 v82, 16, v145
    v_and_b32 v83, 0xffff0000, v145
    v_lshlrev_b32 v90, 16, v149
    v_and_b32 v91, 0xffff0000, v149
    v_lshlrev_b32 v84, 16, v146
    v_and_b32 v85, 0xffff0000, v146
    v_lshlrev_b32 v92, 16, v150
    v_and_b32 v93, 0xffff0000, v150
    v_lshlrev_b32 v86, 16, v147
    v_and_b32 v87, 0xffff0000, v147
    v_lshlrev_b32 v94, 16, v151
    v_and_b32 v95, 0xffff0000, v151
    v_pk_mul_f32 v[88:89], v[88:89], v[80:81] neg_lo:[1,0] neg_hi:[1,0]
    v_pk_mul_f32 v[90:91], v[90:91], v[82:83] neg_lo:[1,0] neg_hi:[1,0]
    v_pk_mul_f32 v[92:93], v[92:93], v[84:85] neg_lo:[1,0] neg_hi:[1,0]
    v_pk_mul_f32 v[94:95], v[94:95], v[86:87] neg_lo:[1,0] neg_hi:[1,0]
    v_cvt_f32_i32 v32, v32
    v_cvt_f32_i32 v33, v33
    v_cvt_f32_i32 v34, v34
    v_cvt_f32_i32 v35, v35
    v_cvt_f32_i32 v36, v36
    v_cvt_f32_i32 v37, v37
    v_cvt_f32_i32 v38, v38
    v_cvt_f32_i32 v39, v39
    v_pk_fma_f32 v[32:33], v[32:33], v[80:81], v[88:89]
    v_pk_fma_f32 v[34:35], v[34:35], v[82:83], v[90:91]
    v_pk_fma_f32 v[36:37], v[36:37], v[84:85], v[92:93]
    v_pk_fma_f32 v[38:39], v[38:39], v[86:87], v[94:95]
    v_cvt_pk_bf16_f32 v108, v32, v33
    v_cvt_pk_bf16_f32 v109, v34, v35
    v_cvt_pk_bf16_f32 v110, v36, v37
    v_cvt_pk_bf16_f32 v111, v38, v39
    buffer_store_dwordx4 v[108:111], v10, s[24:27], s94 offen sc1
L_dskip_1:
    s_add_u32 s86, s86, 98304
    s_cmp_eq_u32 s86, s87
    s_cselect_b32 s86, s55, s86
    s_add_u32 m0, s57, 4096
    s_nop 0
    buffer_load_dwordx4 v2, s[32:35], s86 offen offset:0 lds
    buffer_load_dwordx4 v3, s[32:35], s86 offen offset:1024 lds
    buffer_load_dwordx4 v4, s[32:35], s86 offen offset:2048 lds
    buffer_load_dwordx4 v5, s[32:35], s86 offen offset:3072 lds
    s_add_u32 s86, s86, 98304
    s_cmp_eq_u32 s86, s87
    s_cselect_b32 s86, s55, s86
    s_add_u32 m0, s57, 8192
    s_nop 0
    buffer_load_dwordx4 v2, s[32:35], s86 offen offset:0 lds
    buffer_load_dwordx4 v3, s[32:35], s86 offen offset:1024 lds
    buffer_load_dwordx4 v4, s[32:35], s86 offen offset:2048 lds
    buffer_load_dwordx4 v5, s[32:35], s86 offen offset:3072 lds
    s_add_u32 s86, s86, 98304
    s_cmp_eq_u32 s86, s87
    s_cselect_b32 s86, s55, s86
    s_add_u32 m0, s57, 12288
    s_nop 0
    buffer_load_dwordx4 v2, s[32:35], s86 offen offset:0 lds
    buffer_load_dwordx4 v3, s[32:35], s86 offen offset:1024 lds
    buffer_load_dwordx4 v4, s[32:35], s86 offen offset:2048 lds
    buffer_load_dwordx4 v5, s[32:35], s86 offen offset:3072 lds
    s_waitcnt vmcnt(12)
    s_barrier
    s_cmp_lg_u32 s44, 0
    s_cbranch_scc1 L_nf_2
    v_mov_b32 v186, s80
    v_mov_b32 v187, s62
    v_mov_b32 v188, 0
    s_mov_b64 s[84:85], exec
    s_mov_b64 exec, 1
    buffer_store_dwordx2 v[186:187], v188, s[24:27], s58 offen sc1
    s_mov_b64 exec, s[84:85]
L_nf_2:
    s_add_u32 s86, s86, 98304
    s_cmp_eq_u32 s86, s87
    s_cselect_b32 s86, s55, s86
    s_add_u32 m0, s57, 16384
    s_nop 0
    buffer_load_dwordx4 v2, s[32:35], s86 offen offset:0 lds
    buffer_load_dwordx4 v3, s[32:35], s86 offen offset:1024 lds
    buffer_load_dwordx4 v4, s[32:35], s86 offen offset:2048 lds
    buffer_load_dwordx4 v5, s[32:35], s86 offen offset:3072 lds
    s_add_u32 s86, s86, 98304
    s_cmp_eq_u32 s86, s87
    s_cselect_b32 s86, s55, s86
    s_add_u32 m0, s57, 20480
    s_nop 0
    buffer_load_dwordx4 v2, s[32:35], s86 offen offset:0 lds
    buffer_load_dwordx4 v3, s[32:35], s86 offen offset:1024 lds
    buffer_load_dwordx4 v4, s[32:35], s86 offen offset:2048 lds
    buffer_load_dwordx4 v5, s[32:35], s86 offen offset:3072 lds
    s_add_u32 s86, s86, 98304
    s_cmp_eq_u32 s86, s87
    s_cselect_b32 s86, s55, s86
    s_add_u32 m0, s57, 24576
    s_nop 0
    buffer_load_dwordx4 v2, s[32:35], s86 offen offset:0 lds
    buffer_load_dwordx4 v3, s[32:35], s86 offen offset:1024 lds
    buffer_load_dwordx4 v4, s[32:35], s86 offen offset:2048 lds
    buffer_load_dwordx4 v5, s[32:35], s86 offen offset:3072 lds
    s_add_u32 s86, s86, 98304
    s_cmp_eq_u32 s86, s87
    s_cselect_b32 s86, s55, s86
    s_add_u32 m0, s57, 28672
    s_nop 0
    buffer_load_dwordx4 v2, s[32:35], s86 offen offset:0 lds
    buffer_load_dwordx4 v3, s[32:35], s86 offen offset:1024 lds
    buffer_load_dwordx4 v4, s[32:35], s86 offen offset:2048 lds
    buffer_load_dwordx4 v5, s[32:35], s86 offen offset:3072 lds
    s_add_u32 s86, s86, 98304
    s_cmp_eq_u32 s86, s87
    s_cselect_b32 s86, s55, s86
    s_add_u32 m0, s57, 32768
    s_nop 0
    buffer_load_dwordx4 v2, s[32:35], s86 offen offset:0 lds
    buffer_load_dwordx4 v3, s[32:35], s86 offen offset:1024 lds
    buffer_load_dwordx4 v4, s[32:35], s86 offen offset:2048 lds
    buffer_load_dwordx4 v5, s[32:35], s86 offen offset:3072 lds
    s_add_u32 s86, s86, 98304
    s_cmp_eq_u32 s86, s87
    s_cselect_b32 s86, s55, s86
    s_add_u32 m0, s57, 36864
    s_nop 0
    buffer_load_dwordx4 v2, s[32:35], s86 offen offset:0 lds
    buffer_load_dwordx4 v3, s[32:35], s86 offen offset:1024 lds
    buffer_load_dwordx4 v4, s[32:35], s86 offen offset:2048 lds
    buffer_load_dwordx4 v5, s[32:35], s86 offen offset:3072 lds
    v_min_u32 v182, 5, v1
    v_lshlrev_b32 v182, 7, v182
    buffer_load_dwordx2 v[180:181], v182, s[24:27], s59 offen sc1
    s_waitcnt vmcnt(0)
    s_movk_i32 s63, 20000
L_spin_3:
    v_cmp_ne_u32 vcc, s80, v180
    v_cmp_ne_u32 s[84:85], s62, v181
    s_or_b64 vcc, vcc, s[84:85]
    s_cbranch_vccz L_ok_4
    s_sub_u32 s63, s63, 1
    s_cmp_eq_u32 s63, 0
    s_cbranch_scc1 L_ok_4
    buffer_load_dwordx2 v[180:181], v182, s[24:27], s59 offen sc1
    s_waitcnt vmcnt(0)
    s_branch L_spin_3
L_ok_4:
    buffer_load_dwordx4 a[0:3], v10, s[24:27], s88 offen sc1
    s_add_u32 s50, s88, 49152
    buffer_load_dwordx4 a[4:7], v10, s[24:27], s50 offen sc1
    s_add_u32 s50, s88, 98304
    buffer_load_dwordx4 a[8:11], v10, s[24:27], s50 offen sc1
    s_add_u32 s50, s88, 147456
    buffer_load_dwordx4 a[12:15], v10, s[24:27], s50 offen sc1
    s_add_u32 s50, s88, 196608
    buffer_load_dwordx4 a[16:19], v10, s[24:27], s50 offen sc1
    s_add_u32 s88, s88, 1024
    s_cmp_eq_u32 s88, s90
    s_cselect_b32 s88, s56, s88
    buffer_load_dwordx4 a[20:23], v10, s[24:27], s88 offen sc1
    s_add_u32 s50, s88, 49152
    buffer_load_dwordx4 a[24:27], v10, s[24:27], s50 offen sc1
    s_add_u32 s50, s88, 98304
    buffer_load_dwordx4 a[28:31], v10, s[24:27], s50 offen sc1
    s_add_u32 s50, s88, 147456
    buffer_load_dwordx4 a[32:35], v10, s[24:27], s50 offen sc1
    s_add_u32 s50, s88, 196608
    buffer_load_dwordx4 a[36:39], v10, s[24:27], s50 offen sc1
    s_add_u32 s88, s88, 1024
    s_cmp_eq_u32 s88, s90
    s_cselect_b32 s88, s56, s88
    buffer_load_dwordx4 a[40:43], v10, s[24:27], s88 offen sc1
    s_add_u32 s50, s88, 49152
    buffer_load_dwordx4 a[44:47], v10, s[24:27], s50 offen sc1
    s_add_u32 s50, s88, 98304
    buffer_load_dwordx4 a[48:51], v10, s[24:27], s50 offen sc1
    s_add_u32 s50, s88, 147456
    buffer_load_dwordx4 a[52:55], v10, s[24:27], s50 offen sc1
    s_add_u32 s50, s88, 196608
    buffer_load_dwordx4 a[56:59], v10, s[24:27], s50 offen sc1
    s_add_u32 s88, s88, 1024
    s_cmp_eq_u32 s88, s90
    s_cselect_b32 s88, s56, s88
    buffer_load_dwordx4 a[60:63], v10, s[24:27], s88 offen sc1
    s_add_u32 s50, s88, 49152
    buffer_load_dwordx4 a[64:67], v10, s[24:27], s50 offen sc1
    s_add_u32 s50, s88, 98304
    buffer_load_dwordx4 a[68:71], v10, s[24:27], s50 offen sc1
    s_add_u32 s50, s88, 147456
    buffer_load_dwordx4 a[72:75], v10, s[24:27], s50 offen sc1
    s_add_u32 s50, s88, 196608
    buffer_load_dwordx4 a[76:79], v10, s[24:27], s50 offen sc1
    ds_read_b64_tr_b16 v[96:97], v6 offset:0
    ds_read_b64_tr_b16 v[98:99], v6 offset:512
    ds_read_b64_tr_b16 v[100:101], v7 offset:0
    ds_read_b64_tr_b16 v[102:103], v7 offset:512
    ds_read_b64_tr_b16 v[104:105], v8 offset:0
    ds_read_b64_tr_b16 v[106:107], v8 offset:512
    ds_read_b64_tr_b16 v[108:109], v9 offset:0
    ds_read_b64_tr_b16 v[110:111], v9 offset:512
    v_add_u32 v11, s57, v10
    s_sub_u32 s50, s44, 1
    s_and_b32 s50, s50, 3
    s_mul_i32 s50, s50, 40960
    s_add_u32 s50, s50, 0
    v_add_u32 v12, s50, v10
    s_sub_u32 s50, s44, 2
    s_and_b32 s50, s50, 3
    s_mul_i32 s50, s50, 40960
    s_add_u32 s50, s50, 5120
    v_add_u32 v13, s50, v10
    s_sub_u32 s50, s44, 3
    s_and_b32 s50, s50, 3
    s_mul_i32 s50, s50, 40960
    s_add_u32 s50, s50, 10240
    v_add_u32 v14, s50, v10
    s_waitcnt vmcnt(15)
    s_waitcnt lgkmcnt(0)
    v_mfma_f32_16x16x32_bf16 v[16:19], a[0:3], v[96:99], 0
    ds_read_b64_tr_b16 v[112:113], v6 offset:4096
    v_mfma_f32_16x16x32_bf16 v[36:39], a[0:3], v[100:103], 0
    v_mfma_f32_16x16x32_bf16 v[56:59], a[0:3], v[104:107], 0
    ds_read_b64_tr_b16 v[114:115], v6 offset:4608
    v_mfma_f32_16x16x32_bf16 v[76:79], a[0:3], v[108:111], 0
    s_add_u32 s88, s88, 1024
    s_cmp_eq_u32 s88, s90
    s_cselect_b32 s88, s56, s88
    buffer_load_dwordx4 a[0:3], v10, s[24:27], s88 offen sc1
    v_mfma_f32_16x16x32_bf16 v[20:23], a[4:7], v[96:99], 0
    ds_read_b64_tr_b16 v[116:117], v7 offset:4096
    v_mfma_f32_16x16x32_bf16 v[40:43], a[4:7], v[100:103], 0
    s_add_u32 s86, s86, 98304
    s_cmp_eq_u32 s86, s87
    s_cselect_b32 s86, s55, s86
    s_add_u32 m0, s57, 0
    s_nop 0
    buffer_load_dwordx4 v2, s[32:35], s86 offen offset:0 lds
    v_mfma_f32_16x16x32_bf16 v[60:63], a[4:7], v[104:107], 0
    ds_read_b64_tr_b16 v[118:119], v7 offset:4608
    v_mfma_f32_16x16x32_bf16 v[80:83], a[4:7], v[108:111], 0
    s_add_u32 s50, s88, 49152
    buffer_load_dwordx4 a[4:7], v10, s[24:27], s50 offen sc1
    v_mfma_f32_16x16x32_bf16 v[24:27], a[8:11], v[96:99], 0
    ds_read_b64_tr_b16 v[120:121], v8 offset:4096
    v_mfma_f32_16x16x32_bf16 v[44:47], a[8:11], v[100:103], 0
    v_mfma_f32_16x16x32_bf16 v[64:67], a[8:11], v[104:107], 0
    ds_read_b64_tr_b16 v[122:123], v8 offset:4608
    v_mfma_f32_16x16x32_bf16 v[84:87], a[8:11], v[108:111], 0
    s_add_u32 s50, s88, 98304
    buffer_load_dwordx4 a[8:11], v10, s[24:27], s50 offen sc1
    v_mfma_f32_16x16x32_bf16 v[28:31], a[12:15], v[96:99], 0
    ds_read_b64_tr_b16 v[124:125], v9 offset:4096
    v_mfma_f32_16x16x32_bf16 v[48:51], a[12:15], v[100:103], 0
    s_add_u32 m0, s57, 0
    s_nop 0
    buffer_load_dwordx4 v3, s[32:35], s86 offen offset:1024 lds
    v_mfma_f32_16x16x32_bf16 v[68:71], a[12:15], v[104:107], 0
    ds_read_b64_tr_b16 v[126:127], v9 offset:4608
    v_mfma_f32_16x16x32_bf16 v[88:91], a[12:15], v[108:111], 0
    s_add_u32 s50, s88, 147456
    buffer_load_dwordx4 a[12:15], v10, s[24:27], s50 offen sc1
    v_mfma_f32_16x16x32_bf16 v[32:35], a[16:19], v[96:99], 0
    v_mfma_f32_16x16x32_bf16 v[52:55], a[16:19], v[100:103], 0
    v_mfma_f32_16x16x32_bf16 v[72:75], a[16:19], v[104:107], 0
    v_mfma_f32_16x16x32_bf16 v[92:95], a[16:19], v[108:111], 0
    s_add_u32 s50, s88, 196608
    buffer_load_dwordx4 a[16:19], v10, s[24:27], s50 offen sc1
    s_waitcnt vmcnt(17)
    s_waitcnt lgkmcnt(0)
    v_mfma_f32_16x16x32_bf16 v[16:19], a[20:23], v[112:115], v[16:19]
    ds_read_b64_tr_b16 v[96:97], v6 offset:8192
    v_mfma_f32_16x16x32_bf16 v[36:39], a[20:23], v[116:119], v[36:39]
    v_mfma_f32_16x16x32_bf16 v[56:59], a[20:23], v[120:123], v[56:59]
    ds_read_b64_tr_b16 v[98:99], v6 offset:8704
    v_mfma_f32_16x16x32_bf16 v[76:79], a[20:23], v[124:127], v[76:79]
    s_add_u32 s88, s88, 1024
    s_cmp_eq_u32 s88, s90
    s_cselect_b32 s88, s56, s88
    buffer_load_dwordx4 a[20:23], v10, s[24:27], s88 offen sc1
    v_mfma_f32_16x16x32_bf16 v[20:23], a[24:27], v[112:115], v[20:23]
    ds_read_b64_tr_b16 v[100:101], v7 offset:8192
    v_mfma_f32_16x16x32_bf16 v[40:43], a[24:27], v[116:119], v[40:43]
    s_add_u32 m0, s57, 0
    s_nop 0
    buffer_load_dwordx4 v4, s[32:35], s86 offen offset:2048 lds
    v_mfma_f32_16x16x32_bf16 v[60:63], a[24:27], v[120:123], v[60:63]
    ds_read_b64_tr_b16 v[102:103], v7 offset:8704
    v_mfma_f32_16x16x32_bf16 v[80:83], a[24:27], v[124:127], v[80:83]
    s_add_u32 s50, s88, 49152
    buffer_load_dwordx4 a[24:27], v10, s[24:27], s50 offen sc1
    v_mfma_f32_16x16x32_bf16 v[24:27], a[28:31], v[112:115], v[24:27]
    ds_read_b64_tr_b16 v[104:105], v8 offset:8192
    v_mfma_f32_16x16x32_bf16 v[44:47], a[28:31], v[116:119], v[44:47]
    v_mfma_f32_16x16x32_bf16 v[64:67], a[28:31], v[120:123], v[64:67]
    ds_read_b64_tr_b16 v[106:107], v8 offset:8704
    v_mfma_f32_16x16x32_bf16 v[84:87], a[28:31], v[124:127], v[84:87]
    s_add_u32 s50, s88, 98304
    buffer_load_dwordx4 a[28:31], v10, s[24:27], s50 offen sc1
    v_mfma_f32_16x16x32_bf16 v[28:31], a[32:35], v[112:115], v[28:31]
    ds_read_b64_tr_b16 v[108:109], v9 offset:8192
    v_mfma_f32_16x16x32_bf16 v[48:51], a[32:35], v[116:119], v[48:51]
    s_add_u32 m0, s57, 0
    s_nop 0
    buffer_load_dwordx4 v5, s[32:35], s86 offen offset:3072 lds
    v_mfma_f32_16x16x32_bf16 v[68:71], a[32:35], v[120:123], v[68:71]
    ds_read_b64_tr_b16 v[110:111], v9 offset:8704
    v_mfma_f32_16x16x32_bf16 v[88:91], a[32:35], v[124:127], v[88:91]
    s_add_u32 s50, s88, 147456
    buffer_load_dwordx4 a[32:35], v10, s[24:27], s50 offen sc1
    v_mfma_f32_16x16x32_bf16 v[32:35], a[36:39], v[112:115], v[32:35]
    v_mfma_f32_16x16x32_bf16 v[52:55], a[36:39], v[116:119], v[52:55]
    v_mfma_f32_16x16x32_bf16 v[72:75], a[36:39], v[120:123], v[72:75]
    v_mfma_f32_16x16x32_bf16 v[92:95], a[36:39], v[124:127], v[92:95]
    s_add_u32 s50, s88, 196608
    buffer_load_dwordx4 a[36:39], v10, s[24:27], s50 offen sc1
    s_waitcnt vmcnt(19)
    s_waitcnt lgkmcnt(0)
    v_mfma_f32_16x16x32_bf16 v[16:19], a[40:43], v[96:99], v[16:19]
    ds_read_b64_tr_b16 v[112:113], v6 offset:12288
    v_mfma_f32_16x16x32_bf16 v[36:39], a[40:43], v[100:103], v[36:39]
    v_mfma_f32_16x16x32_bf16 v[56:59], a[40:43], v[104:107], v[56:59]
    ds_read_b64_tr_b16 v[114:115], v6 offset:12800
    v_mfma_f32_16x16x32_bf16 v[76:79], a[40:43], v[108:111], v[76:79]
    s_add_u32 s88, s88, 1024
    s_cmp_eq_u32 s88, s90
    s_cselect_b32 s88, s56, s88
    buffer_load_dwordx4 a[40:43], v10, s[24:27], s88 offen sc1
    v_mfma_f32_16x16x32_bf16 v[20:23], a[44:47], v[96:99], v[20:23]
    ds_read_b64_tr_b16 v[116:117], v7 offset:12288
    v_mfma_f32_16x16x32_bf16 v[40:43], a[44:47], v[100:103], v[40:43]
    s_add_u32 s86, s86, 98304
    s_cmp_eq_u32 s86, s87
    s_cselect_b32 s86, s55, s86
    s_add_u32 m0, s57, 4096
    s_nop 0
    buffer_load_dwordx4 v2, s[32:35], s86 offen offset:0 lds
    v_mfma_f32_16x16x32_bf16 v[60:63], a[44:47], v[104:107], v[60:63]
    ds_read_b64_tr_b16 v[118:119], v7 offset:12800
    v_mfma_f32_16x16x32_bf16 v[80:83], a[44:47], v[108:111], v[80:83]
    s_add_u32 s50, s88, 49152
    buffer_load_dwordx4 a[44:47], v10, s[24:27], s50 offen sc1
    v_mfma_f32_16x16x32_bf16 v[24:27], a[48:51], v[96:99], v[24:27]
    ds_read_b64_tr_b16 v[120:121], v8 offset:12288
    v_mfma_f32_16x16x32_bf16 v[44:47], a[48:51], v[100:103], v[44:47]
    v_mfma_f32_16x16x32_bf16 v[64:67], a[48:51], v[104:107], v[64:67]
    ds_read_b64_tr_b16 v[122:123], v8 offset:12800
    v_mfma_f32_16x16x32_bf16 v[84:87], a[48:51], v[108:111], v[84:87]
    s_add_u32 s50, s88, 98304
    buffer_load_dwordx4 a[48:51], v10, s[24:27], s50 offen sc1
    v_mfma_f32_16x16x32_bf16 v[28:31], a[52:55], v[96:99], v[28:31]
    ds_read_b64_tr_b16 v[124:125], v9 offset:12288
    v_mfma_f32_16x16x32_bf16 v[48:51], a[52:55], v[100:103], v[48:51]
    s_add_u32 m0, s57, 4096
    s_nop 0
    buffer_load_dwordx4 v3, s[32:35], s86 offen offset:1024 lds
    v_mfma_f32_16x16x32_bf16 v[68:71], a[52:55], v[104:107], v[68:71]
    ds_read_b64_tr_b16 v[126:127], v9 offset:12800
    v_mfma_f32_16x16x32_bf16 v[88:91], a[52:55], v[108:111], v[88:91]
    s_add_u32 s50, s88, 147456
    buffer_load_dwordx4 a[52:55], v10, s[24:27], s50 offen sc1
    v_mfma_f32_16x16x32_bf16 v[32:35], a[56:59], v[96:99], v[32:35]
    v_mfma_f32_16x16x32_bf16 v[52:55], a[56:59], v[100:103], v[52:55]
    v_mfma_f32_16x16x32_bf16 v[72:75], a[56:59], v[104:107], v[72:75]
    v_mfma_f32_16x16x32_bf16 v[92:95], a[56:59], v[108:111], v[92:95]
    s_add_u32 s50, s88, 196608
    buffer_load_dwordx4 a[56:59], v10, s[24:27], s50 offen sc1
    s_waitcnt vmcnt(21)
    s_waitcnt lgkmcnt(0)
    v_mfma_f32_16x16x32_bf16 v[16:19], a[60:63], v[112:115], v[16:19]
    ds_read_b64_tr_b16 v[96:97], v6 offset:16384
    v_mfma_f32_16x16x32_bf16 v[36:39], a[60:63], v[116:119], v[36:39]
    v_mfma_f32_16x16x32_bf16 v[56:59], a[60:63], v[120:123], v[56:59]
    ds_read_b64_tr_b16 v[98:99], v6 offset:16896
    v_mfma_f32_16x16x32_bf16 v[76:79], a[60:63], v[124:127], v[76:79]
    s_add_u32 s88, s88, 1024
    s_cmp_eq_u32 s88, s90
    s_cselect_b32 s88, s56, s88
    buffer_load_dwordx4 a[60:63], v10, s[24:27], s88 offen sc1
    v_mfma_f32_16x16x32_bf16 v[20:23], a[64:67], v[112:115], v[20:23]
    ds_read_b64_tr_b16 v[100:101], v7 offset:16384
    v_mfma_f32_16x16x32_bf16 v[40:43], a[64:67], v[116:119], v[40:43]
    s_add_u32 m0, s57, 4096
    s_nop 0
    buffer_load_dwordx4 v4, s[32:35], s86 offen offset:2048 lds
    v_mfma_f32_16x16x32_bf16 v[60:63], a[64:67], v[120:123], v[60:63]
    ds_read_b64_tr_b16 v[102:103], v7 offset:16896
    v_mfma_f32_16x16x32_bf16 v[80:83], a[64:67], v[124:127], v[80:83]
    s_add_u32 s50, s88, 49152
    buffer_load_dwordx4 a[64:67], v10, s[24:27], s50 offen sc1
    v_mfma_f32_16x16x32_bf16 v[24:27], a[68:71], v[112:115], v[24:27]
    ds_read_b64_tr_b16 v[104:105], v8 offset:16384
    v_mfma_f32_16x16x32_bf16 v[44:47], a[68:71], v[116:119], v[44:47]
    v_mfma_f32_16x16x32_bf16 v[64:67], a[68:71], v[120:123], v[64:67]
    ds_read_b64_tr_b16 v[106:107], v8 offset:16896
    v_mfma_f32_16x16x32_bf16 v[84:87], a[68:71], v[124:127], v[84:87]
    s_add_u32 s50, s88, 98304
    buffer_load_dwordx4 a[68:71], v10, s[24:27], s50 offen sc1
    v_mfma_f32_16x16x32_bf16 v[28:31], a[72:75], v[112:115], v[28:31]
    ds_read_b64_tr_b16 v[108:109], v9 offset:16384
    v_mfma_f32_16x16x32_bf16 v[48:51], a[72:75], v[116:119], v[48:51]
    s_add_u32 m0, s57, 4096
    s_nop 0
    buffer_load_dwordx4 v5, s[32:35], s86 offen offset:3072 lds
    v_mfma_f32_16x16x32_bf16 v[68:71], a[72:75], v[120:123], v[68:71]
    ds_read_b64_tr_b16 v[110:111], v9 offset:16896
    v_mfma_f32_16x16x32_bf16 v[88:91], a[72:75], v[124:127], v[88:91]
    s_add_u32 s50, s88, 147456
    buffer_load_dwordx4 a[72:75], v10, s[24:27], s50 offen sc1
    v_mfma_f32_16x16x32_bf16 v[32:35], a[76:79], v[112:115], v[32:35]
    v_mfma_f32_16x16x32_bf16 v[52:55], a[76:79], v[116:119], v[52:55]
    v_mfma_f32_16x16x32_bf16 v[72:75], a[76:79], v[120:123], v[72:75]
    v_mfma_f32_16x16x32_bf16 v[92:95], a[76:79], v[124:127], v[92:95]
    s_add_u32 s50, s88, 196608
    buffer_load_dwordx4 a[76:79], v10, s[24:27], s50 offen sc1
    s_waitcnt vmcnt(21)
    s_waitcnt lgkmcnt(0)
    v_mfma_f32_16x16x32_bf16 v[16:19], a[0:3], v[96:99], v[16:19]
    ds_read_b64_tr_b16 v[112:113], v6 offset:20480
    v_mfma_f32_16x16x32_bf16 v[36:39], a[0:3], v[100:103], v[36:39]
    v_mfma_f32_16x16x32_bf16 v[56:59], a[0:3], v[104:107], v[56:59]
    ds_read_b64_tr_b16 v[114:115], v6 offset:20992
    v_mfma_f32_16x16x32_bf16 v[76:79], a[0:3], v[108:111], v[76:79]
    s_add_u32 s88, s88, 1024
    s_cmp_eq_u32 s88, s90
    s_cselect_b32 s88, s56, s88
    buffer_load_dwordx4 a[0:3], v10, s[24:27], s88 offen sc1
    v_mfma_f32_16x16x32_bf16 v[20:23], a[4:7], v[96:99], v[20:23]
    ds_read_b64_tr_b16 v[116:117], v7 offset:20480
    v_mfma_f32_16x16x32_bf16 v[40:43], a[4:7], v[100:103], v[40:43]
    v_mfma_f32_16x16x32_bf16 v[60:63], a[4:7], v[104:107], v[60:63]
    ds_read_b64_tr_b16 v[118:119], v7 offset:20992
    v_mfma_f32_16x16x32_bf16 v[80:83], a[4:7], v[108:111], v[80:83]
    s_add_u32 s50, s88, 49152
    buffer_load_dwordx4 a[4:7], v10, s[24:27], s50 offen sc1
    v_mfma_f32_16x16x32_bf16 v[24:27], a[8:11], v[96:99], v[24:27]
    ds_read_b64_tr_b16 v[120:121], v8 offset:20480
    v_mfma_f32_16x16x32_bf16 v[44:47], a[8:11], v[100:103], v[44:47]
    v_mfma_f32_16x16x32_bf16 v[64:67], a[8:11], v[104:107], v[64:67]
    ds_read_b64_tr_b16 v[122:123], v8 offset:20992
    v_mfma_f32_16x16x32_bf16 v[84:87], a[8:11], v[108:111], v[84:87]
    s_add_u32 s50, s88, 98304
    buffer_load_dwordx4 a[8:11], v10, s[24:27], s50 offen sc1
    v_mfma_f32_16x16x32_bf16 v[28:31], a[12:15], v[96:99], v[28:31]
    ds_read_b64_tr_b16 v[124:125], v9 offset:20480
    v_mfma_f32_16x16x32_bf16 v[48:51], a[12:15], v[100:103], v[48:51]
    v_mfma_f32_16x16x32_bf16 v[68:71], a[12:15], v[104:107], v[68:71]
    ds_read_b64_tr_b16 v[126:127], v9 offset:20992
    v_mfma_f32_16x16x32_bf16 v[88:91], a[12:15], v[108:111], v[88:91]
    s_add_u32 s50, s88, 147456
    buffer_load_dwordx4 a[12:15], v10, s[24:27], s50 offen sc1
    v_mfma_f32_16x16x32_bf16 v[32:35], a[16:19], v[96:99], v[32:35]
    v_mfma_f32_16x16x32_bf16 v[52:55], a[16:19], v[100:103], v[52:55]
    v_mfma_f32_16x16x32_bf16 v[72:75], a[16:19], v[104:107], v[72:75]
    v_mfma_f32_16x16x32_bf16 v[92:95], a[16:19], v[108:111], v[92:95]
    s_add_u32 s50, s88, 196608
    buffer_load_dwordx4 a[16:19], v10, s[24:27], s50 offen sc1
    s_waitcnt vmcnt(19)
    s_waitcnt lgkmcnt(0)
    v_mfma_f32_16x16x32_bf16 v[16:19], a[20:23], v[112:115], v[16:19]
    ds_read_b64_tr_b16 v[96:97], v6 offset:24576
    v_mfma_f32_16x16x32_bf16 v[36:39], a[20:23], v[116:119], v[36:39]
    v_mfma_f32_16x16x32_bf16 v[56:59], a[20:23], v[120:123], v[56:59]
    ds_read_b64_tr_b16 v[98:99], v6 offset:25088
    v_mfma_f32_16x16x32_bf16 v[76:79], a[20:23], v[124:127], v[76:79]
    s_add_u32 s88, s88, 1024
    s_cmp_eq_u32 s88, s90
    s_cselect_b32 s88, s56, s88
    buffer_load_dwordx4 a[20:23], v10, s[24:27], s88 offen sc1
    v_mfma_f32_16x16x32_bf16 v[20:23], a[24:27], v[112:115], v[20:23]
    ds_read_b64_tr_b16 v[100:101], v7 offset:24576
    v_mfma_f32_16x16x32_bf16 v[40:43], a[24:27], v[116:119], v[40:43]
    v_mfma_f32_16x16x32_bf16 v[60:63], a[24:27], v[120:123], v[60:63]
    ds_read_b64_tr_b16 v[102:103], v7 offset:25088
    v_mfma_f32_16x16x32_bf16 v[80:83], a[24:27], v[124:127], v[80:83]
    s_add_u32 s50, s88, 49152
    buffer_load_dwordx4 a[24:27], v10, s[24:27], s50 offen sc1
    v_mfma_f32_16x16x32_bf16 v[24:27], a[28:31], v[112:115], v[24:27]
    ds_read_b64_tr_b16 v[104:105], v8 offset:24576
    v_mfma_f32_16x16x32_bf16 v[44:47], a[28:31], v[116:119], v[44:47]
    v_mfma_f32_16x16x32_bf16 v[64:67], a[28:31], v[120:123], v[64:67]
    ds_read_b64_tr_b16 v[106:107], v8 offset:25088
    v_mfma_f32_16x16x32_bf16 v[84:87], a[28:31], v[124:127], v[84:87]
    s_add_u32 s50, s88, 98304
    buffer_load_dwordx4 a[28:31], v10, s[24:27], s50 offen sc1
    v_mfma_f32_16x16x32_bf16 v[28:31], a[32:35], v[112:115], v[28:31]
    ds_read_b64_tr_b16 v[108:109], v9 offset:24576
    v_mfma_f32_16x16x32_bf16 v[48:51], a[32:35], v[116:119], v[48:51]
    v_mfma_f32_16x16x32_bf16 v[68:71], a[32:35], v[120:123], v[68:71]
    ds_read_b64_tr_b16 v[110:111], v9 offset:25088
    v_mfma_f32_16x16x32_bf16 v[88:91], a[32:35], v[124:127], v[88:91]
    s_add_u32 s50, s88, 147456
    buffer_load_dwordx4 a[32:35], v10, s[24:27], s50 offen sc1
    v_mfma_f32_16x16x32_bf16 v[32:35], a[36:39], v[112:115], v[32:35]
    v_mfma_f32_16x16x32_bf16 v[52:55], a[36:39], v[116:119], v[52:55]
    v_mfma_f32_16x16x32_bf16 v[72:75], a[36:39], v[120:123], v[72:75]
    v_mfma_f32_16x16x32_bf16 v[92:95], a[36:39], v[124:127], v[92:95]
    s_add_u32 s50, s88, 196608
    buffer_load_dwordx4 a[36:39], v10, s[24:27], s50 offen sc1
    s_waitcnt vmcnt(17)
    s_waitcnt lgkmcnt(0)
    v_mfma_f32_16x16x32_bf16 v[16:19], a[40:43], v[96:99], v[16:19]
    ds_read_b64_tr_b16 v[112:113], v6 offset:28672
    v_mfma_f32_16x16x32_bf16 v[36:39], a[40:43], v[100:103], v[36:39]
    v_mfma_f32_16x16x32_bf16 v[56:59], a[40:43], v[104:107], v[56:59]
    ds_read_b64_tr_b16 v[114:115], v6 offset:29184
    v_mfma_f32_16x16x32_bf16 v[76:79], a[40:43], v[108:111], v[76:79]
    s_add_u32 s88, s88, 1024
    s_cmp_eq_u32 s88, s90
    s_cselect_b32 s88, s56, s88
    buffer_load_dwordx4 a[40:43], v10, s[24:27], s88 offen sc1
    v_mfma_f32_16x16x32_bf16 v[20:23], a[44:47], v[96:99], v[20:23]
    ds_read_b64_tr_b16 v[116:117], v7 offset:28672
    v_mfma_f32_16x16x32_bf16 v[40:43], a[44:47], v[100:103], v[40:43]
    v_mfma_f32_16x16x32_bf16 v[60:63], a[44:47], v[104:107], v[60:63]
    ds_read_b64_tr_b16 v[118:119], v7 offset:29184
    v_mfma_f32_16x16x32_bf16 v[80:83], a[44:47], v[108:111], v[80:83]
    s_add_u32 s50, s88, 49152
    buffer_load_dwordx4 a[44:47], v10, s[24:27], s50 offen sc1
    v_mfma_f32_16x16x32_bf16 v[24:27], a[48:51], v[96:99], v[24:27]
    ds_read_b64_tr_b16 v[120:121], v8 offset:28672
    v_mfma_f32_16x16x32_bf16 v[44:47], a[48:51], v[100:103], v[44:47]
    v_mfma_f32_16x16x32_bf16 v[64:67], a[48:51], v[104:107], v[64:67]
    ds_read_b64_tr_b16 v[122:123], v8 offset:29184
    v_mfma_f32_16x16x32_bf16 v[84:87], a[48:51], v[108:111], v[84:87]
    s_add_u32 s50, s88, 98304
    buffer_load_dwordx4 a[48:51], v10, s[24:27], s50 offen sc1
    v_mfma_f32_16x16x32_bf16 v[28:31], a[52:55], v[96:99], v[28:31]
    ds_read_b64_tr_b16 v[124:125], v9 offset:28672
    v_mfma_f32_16x16x32_bf16 v[48:51], a[52:55], v[100:103], v[48:51]
    v_mfma_f32_16x16x32_bf16 v[68:71], a[52:55], v[104:107], v[68:71]
    ds_read_b64_tr_b16 v[126:127], v9 offset:29184
    v_mfma_f32_16x16x32_bf16 v[88:91], a[52:55], v[108:111], v[88:91]
    s_add_u32 s50, s88, 147456
    buffer_load_dwordx4 a[52:55], v10, s[24:27], s50 offen sc1
    v_mfma_f32_16x16x32_bf16 v[32:35], a[56:59], v[96:99], v[32:35]
    v_mfma_f32_16x16x32_bf16 v[52:55], a[56:59], v[100:103], v[52:55]
    v_mfma_f32_16x16x32_bf16 v[72:75], a[56:59], v[104:107], v[72:75]
    v_mfma_f32_16x16x32_bf16 v[92:95], a[56:59], v[108:111], v[92:95]
    s_add_u32 s50, s88, 196608
    buffer_load_dwordx4 a[56:59], v10, s[24:27], s50 offen sc1
    s_waitcnt vmcnt(15)
    s_waitcnt lgkmcnt(0)
    v_mfma_f32_16x16x32_bf16 v[16:19], a[60:63], v[112:115], v[16:19]
    ds_read_b64_tr_b16 v[96:97], v6 offset:32768
    v_mfma_f32_16x16x32_bf16 v[36:39], a[60:63], v[116:119], v[36:39]
    v_mfma_f32_16x16x32_bf16 v[56:59], a[60:63], v[120:123], v[56:59]
    ds_read_b64_tr_b16 v[98:99], v6 offset:33280
    v_mfma_f32_16x16x32_bf16 v[76:79], a[60:63], v[124:127], v[76:79]
    s_add_u32 s88, s88, 1024
    s_cmp_eq_u32 s88, s90
    s_cselect_b32 s88, s56, s88
    buffer_load_dwordx4 a[60:63], v10, s[24:27], s88 offen sc1
    v_mfma_f32_16x16x32_bf16 v[20:23], a[64:67], v[112:115], v[20:23]
    ds_read_b64_tr_b16 v[100:101], v7 offset:32768
    v_mfma_f32_16x16x32_bf16 v[40:43], a[64:67], v[116:119], v[40:43]
    v_mfma_f32_16x16x32_bf16 v[60:63], a[64:67], v[120:123], v[60:63]
    ds_read_b64_tr_b16 v[102:103], v7 offset:33280
    v_mfma_f32_16x16x32_bf16 v[80:83], a[64:67], v[124:127], v[80:83]
    s_add_u32 s50, s88, 49152
    buffer_load_dwordx4 a[64:67], v10, s[24:27], s50 offen sc1
    v_mfma_f32_16x16x32_bf16 v[24:27], a[68:71], v[112:115], v[24:27]
    ds_read_b64_tr_b16 v[104:105], v8 offset:32768
    v_mfma_f32_16x16x32_bf16 v[44:47], a[68:71], v[116:119], v[44:47]
    v_mfma_f32_16x16x32_bf16 v[64:67], a[68:71], v[120:123], v[64:67]
    ds_read_b64_tr_b16 v[106:107], v8 offset:33280
    v_mfma_f32_16x16x32_bf16 v[84:87], a[68:71], v[124:127], v[84:87]
    s_add_u32 s50, s88, 98304
    buffer_load_dwordx4 a[68:71], v10, s[24:27], s50 offen sc1
    v_mfma_f32_16x16x32_bf16 v[28:31], a[72:75], v[112:115], v[28:31]
    ds_read_b64_tr_b16 v[108:109], v9 offset:32768
    v_mfma_f32_16x16x32_bf16 v[48:51], a[72:75], v[116:119], v[48:51]
    v_mfma_f32_16x16x32_bf16 v[68:71], a[72:75], v[120:123], v[68:71]
    ds_read_b64_tr_b16 v[110:111], v9 offset:33280
    v_mfma_f32_16x16x32_bf16 v[88:91], a[72:75], v[124:127], v[88:91]
    s_add_u32 s50, s88, 147456
    buffer_load_dwordx4 a[72:75], v10, s[24:27], s50 offen sc1
    v_mfma_f32_16x16x32_bf16 v[32:35], a[76:79], v[112:115], v[32:35]
    v_mfma_f32_16x16x32_bf16 v[52:55], a[76:79], v[116:119], v[52:55]
    v_mfma_f32_16x16x32_bf16 v[72:75], a[76:79], v[120:123], v[72:75]
    v_mfma_f32_16x16x32_bf16 v[92:95], a[76:79], v[124:127], v[92:95]
    s_add_u32 s50, s88, 196608
    buffer_load_dwordx4 a[76:79], v10, s[24:27], s50 offen sc1
    s_waitcnt vmcnt(15)
    s_waitcnt lgkmcnt(0)
    v_mfma_f32_16x16x32_bf16 v[16:19], a[0:3], v[96:99], v[16:19]
    ds_read_b64_tr_b16 v[112:113], v6 offset:36864
    v_mfma_f32_16x16x32_bf16 v[36:39], a[0:3], v[100:103], v[36:39]
    v_mfma_f32_16x16x32_bf16 v[56:59], a[0:3], v[104:107], v[56:59]
    ds_read_b64_tr_b16 v[114:115], v6 offset:37376
    v_mfma_f32_16x16x32_bf16 v[76:79], a[0:3], v[108:111], v[76:79]
    v_mfma_f32_16x16x32_bf16 v[20:23], a[4:7], v[96:99], v[20:23]
    ds_read_b64_tr_b16 v[116:117], v7 offset:36864
    v_mfma_f32_16x16x32_bf16 v[40:43], a[4:7], v[100:103], v[40:43]
    v_mfma_f32_16x16x32_bf16 v[60:63], a[4:7], v[104:107], v[60:63]
    ds_read_b64_tr_b16 v[118:119], v7 offset:37376
    v_mfma_f32_16x16x32_bf16 v[80:83], a[4:7], v[108:111], v[80:83]
    v_mfma_f32_16x16x32_bf16 v[24:27], a[8:11], v[96:99], v[24:27]
    ds_read_b64_tr_b16 v[120:121], v8 offset:36864
    v_mfma_f32_16x16x32_bf16 v[44:47], a[8:11], v[100:103], v[44:47]
    v_mfma_f32_16x16x32_bf16 v[64:67], a[8:11], v[104:107], v[64:67]
    ds_read_b64_tr_b16 v[122:123], v8 offset:37376
    v_mfma_f32_16x16x32_bf16 v[84:87], a[8:11], v[108:111], v[84:87]
    v_mfma_f32_16x16x32_bf16 v[28:31], a[12:15], v[96:99], v[28:31]
    ds_read_b64_tr_b16 v[124:125], v9 offset:36864
    v_mfma_f32_16x16x32_bf16 v[48:51], a[12:15], v[100:103], v[48:51]
    v_mfma_f32_16x16x32_bf16 v[68:71], a[12:15], v[104:107], v[68:71]
    ds_read_b64_tr_b16 v[126:127], v9 offset:37376
    v_mfma_f32_16x16x32_bf16 v[88:91], a[12:15], v[108:111], v[88:91]
    v_mfma_f32_16x16x32_bf16 v[32:35], a[16:19], v[96:99], v[32:35]
    v_mfma_f32_16x16x32_bf16 v[52:55], a[16:19], v[100:103], v[52:55]
    v_mfma_f32_16x16x32_bf16 v[72:75], a[16:19], v[104:107], v[72:75]
    v_mfma_f32_16x16x32_bf16 v[92:95], a[16:19], v[108:111], v[92:95]
    s_waitcnt vmcnt(10)
    s_waitcnt lgkmcnt(0)
    v_mfma_f32_16x16x32_bf16 v[16:19], a[20:23], v[112:115], v[16:19]
    ds_read_b64_tr_b16 v[96:97], v6 offset:0
    v_mfma_f32_16x16x32_bf16 v[36:39], a[20:23], v[116:119], v[36:39]
    v_mfma_f32_16x16x32_bf16 v[56:59], a[20:23], v[120:123], v[56:59]
    ds_read_b64_tr_b16 v[98:99], v6 offset:512
    v_mfma_f32_16x16x32_bf16 v[76:79], a[20:23], v[124:127], v[76:79]
    v_mfma_f32_16x16x32_bf16 v[20:23], a[24:27], v[112:115], v[20:23]
    ds_read_b64_tr_b16 v[100:101], v7 offset:0
    v_mfma_f32_16x16x32_bf16 v[40:43], a[24:27], v[116:119], v[40:43]
    v_mfma_f32_16x16x32_bf16 v[60:63], a[24:27], v[120:123], v[60:63]
    ds_read_b64_tr_b16 v[102:103], v7 offset:512
    v_mfma_f32_16x16x32_bf16 v[80:83], a[24:27], v[124:127], v[80:83]
    v_mfma_f32_16x16x32_bf16 v[24:27], a[28:31], v[112:115], v[24:27]
    ds_read_b64_tr_b16 v[104:105], v8 offset:0
    v_mfma_f32_16x16x32_bf16 v[44:47], a[28:31], v[116:119], v[44:47]
    v_mfma_f32_16x16x32_bf16 v[64:67], a[28:31], v[120:123], v[64:67]
    ds_read_b64_tr_b16 v[106:107], v8 offset:512
    v_mfma_f32_16x16x32_bf16 v[84:87], a[28:31], v[124:127], v[84:87]
    v_mfma_f32_16x16x32_bf16 v[28:31], a[32:35], v[112:115], v[28:31]
    ds_read_b64_tr_b16 v[108:109], v9 offset:0
    v_mfma_f32_16x16x32_bf16 v[48:51], a[32:35], v[116:119], v[48:51]
    v_mfma_f32_16x16x32_bf16 v[68:71], a[32:35], v[120:123], v[68:71]
    ds_read_b64_tr_b16 v[110:111], v9 offset:512
    v_mfma_f32_16x16x32_bf16 v[88:91], a[32:35], v[124:127], v[88:91]
    v_mfma_f32_16x16x32_bf16 v[32:35], a[36:39], v[112:115], v[32:35]
    v_mfma_f32_16x16x32_bf16 v[52:55], a[36:39], v[116:119], v[52:55]
    v_mfma_f32_16x16x32_bf16 v[72:75], a[36:39], v[120:123], v[72:75]
    v_mfma_f32_16x16x32_bf16 v[92:95], a[36:39], v[124:127], v[92:95]
    s_waitcnt vmcnt(5)
    s_waitcnt lgkmcnt(0)
    v_mfma_f32_16x16x32_bf16 v[16:19], a[40:43], v[96:99], v[16:19]
    ds_read_b64_tr_b16 v[112:113], v6 offset:4096
    v_mfma_f32_16x16x32_bf16 v[36:39], a[40:43], v[100:103], v[36:39]
    v_mfma_f32_16x16x32_bf16 v[56:59], a[40:43], v[104:107], v[56:59]
    ds_read_b64_tr_b16 v[114:115], v6 offset:4608
    v_mfma_f32_16x16x32_bf16 v[76:79], a[40:43], v[108:111], v[76:79]
    v_mfma_f32_16x16x32_bf16 v[20:23], a[44:47], v[96:99], v[20:23]
    ds_read_b64_tr_b16 v[116:117], v7 offset:4096
    v_mfma_f32_16x16x32_bf16 v[40:43], a[44:47], v[100:103], v[40:43]
    v_mfma_f32_16x16x32_bf16 v[60:63], a[44:47], v[104:107], v[60:63]
    ds_read_b64_tr_b16 v[118:119], v7 offset:4608
    v_mfma_f32_16x16x32_bf16 v[80:83], a[44:47], v[108:111], v[80:83]
    v_mfma_f32_16x16x32_bf16 v[24:27], a[48:51], v[96:99], v[24:27]
    ds_read_b64_tr_b16 v[120:121], v8 offset:4096
    v_mfma_f32_16x16x32_bf16 v[44:47], a[48:51], v[100:103], v[44:47]
    v_mfma_f32_16x16x32_bf16 v[64:67], a[48:51], v[104:107], v[64:67]
    ds_read_b64_tr_b16 v[122:123], v8 offset:4608
    v_mfma_f32_16x16x32_bf16 v[84:87], a[48:51], v[108:111], v[84:87]
    v_mfma_f32_16x16x32_bf16 v[28:31], a[52:55], v[96:99], v[28:31]
    ds_read_b64_tr_b16 v[124:125], v9 offset:4096
    v_mfma_f32_16x16x32_bf16 v[48:51], a[52:55], v[100:103], v[48:51]
    v_mfma_f32_16x16x32_bf16 v[68:71], a[52:55], v[104:107], v[68:71]
    ds_read_b64_tr_b16 v[126:127], v9 offset:4608
    v_mfma_f32_16x16x32_bf16 v[88:91], a[52:55], v[108:111], v[88:91]
    v_mfma_f32_16x16x32_bf16 v[32:35], a[56:59], v[96:99], v[32:35]
    v_mfma_f32_16x16x32_bf16 v[52:55], a[56:59], v[100:103], v[52:55]
    v_mfma_f32_16x16x32_bf16 v[72:75], a[56:59], v[104:107], v[72:75]
    v_mfma_f32_16x16x32_bf16 v[92:95], a[56:59], v[108:111], v[92:95]
    s_waitcnt vmcnt(0)
    s_waitcnt lgkmcnt(0)
    v_mfma_f32_16x16x32_bf16 v[36:39], a[60:63], v[116:119], v[36:39]
    v_mfma_f32_16x16x32_bf16 v[40:43], a[64:67], v[116:119], v[40:43]
    v_mfma_f32_16x16x32_bf16 v[44:47], a[68:71], v[116:119], v[44:47]
    v_mfma_f32_16x16x32_bf16 v[48:51], a[72:75], v[116:119], v[48:51]
    v_mfma_f32_16x16x32_bf16 v[52:55], a[76:79], v[116:119], v[52:55]
    v_mfma_f32_16x16x32_bf16 v[56:59], a[60:63], v[120:123], v[56:59]
    v_mfma_f32_16x16x32_bf16 v[60:63], a[64:67], v[120:123], v[60:63]
    v_mfma_f32_16x16x32_bf16 v[64:67], a[68:71], v[120:123], v[64:67]
    v_mfma_f32_16x16x32_bf16 v[68:71], a[72:75], v[120:123], v[68:71]
    ds_write_b128 v11, v[36:39] offset:0
    v_mfma_f32_16x16x32_bf16 v[72:75], a[76:79], v[120:123], v[72:75]
    ds_write_b128 v11, v[40:43] offset:1024
    v_mfma_f32_16x16x32_bf16 v[76:79], a[60:63], v[124:127], v[76:79]
    ds_write_b128 v11, v[44:47] offset:2048
    v_mfma_f32_16x16x32_bf16 v[80:83], a[64:67], v[124:127], v[80:83]
    ds_write_b128 v11, v[48:51] offset:3072
    v_mfma_f32_16x16x32_bf16 v[84:87], a[68:71], v[124:127], v[84:87]
    ds_write_b128 v11, v[52:55] offset:4096
    v_mfma_f32_16x16x32_bf16 v[88:91], a[72:75], v[124:127], v[88:91]
    ds_write_b128 v11, v[56:59] offset:5120
    v_mfma_f32_16x16x32_bf16 v[92:95], a[76:79], v[124:127], v[92:95]
    ds_write_b128 v11, v[60:63] offset:6144
    v_mfma_f32_16x16x32_bf16 v[16:19], a[60:63], v[112:115], v[16:19]
    ds_write_b128 v11, v[64:67] offset:7168
    v_mfma_f32_16x16x32_bf16 v[20:23], a[64:67], v[112:115], v[20:23]
    ds_write_b128 v11, v[68:71] offset:8192
    v_mfma_f32_16x16x32_bf16 v[24:27], a[68:71], v[112:115], v[24:27]
    ds_write_b128 v11, v[72:75] offset:9216
    v_mfma_f32_16x16x32_bf16 v[28:31], a[72:75], v[112:115], v[28:31]
    ds_write_b128 v11, v[76:79] offset:10240
    v_mfma_f32_16x16x32_bf16 v[32:35], a[76:79], v[112:115], v[32:35]
    ds_write_b128 v11, v[80:83] offset:11264
    s_nop 1
    ds_write_b128 v11, v[84:87] offset:12288
    ds_write_b128 v11, v[88:91] offset:13312
    ds_write_b128 v11, v[92:95] offset:14336
    s_waitcnt lgkmcnt(0)
    s_barrier
    ds_read_b128 v[36:39], v12 offset:0
    ds_read_b128 v[40:43], v13 offset:0
    ds_read_b128 v[44:47], v14 offset:0
    ds_read_b128 v[48:51], v12 offset:1024
    ds_read_b128 v[52:55], v13 offset:1024
    ds_read_b128 v[56:59], v14 offset:1024
    ds_read_b128 v[60:63], v12 offset:2048
    ds_read_b128 v[64:67], v13 offset:2048
    ds_read_b128 v[68:71], v14 offset:2048
    ds_read_b128 v[72:75], v12 offset:3072
    ds_read_b128 v[76:79], v13 offset:3072
    ds_read_b128 v[80:83], v14 offset:3072
    ds_read_b128 v[84:87], v12 offset:4096
    ds_read_b128 v[88:91], v13 offset:4096
    ds_read_b128 v[92:95], v14 offset:4096
    v_min_u32 v182, 3, v1
    v_lshlrev_b32 v182, 7, v182
    buffer_load_dwordx2 v[180:181], v182, s[24:27], s60 offen sc1
    s_lshl_b32 s50, s48, 2
    s_add_u32 s50, s50, s44
    s_mul_i32 s50, s50, 20
    s_lshr_b32 s51, s47, 1
    s_mul_i32 s51, s51, 5
    s_add_u32 s50, s50, s51
    s_lshl_b32 s50, s50, 10
    s_add_u32 s50, s50, 2097152
    s_and_b32 s51, s47, 1
    s_lshl_b32 s52, s51, 11
    s_add_u32 s52, s52, s50
    s_lshl_b32 s51, s51, 9
    s_add_u32 s51, s51, s50
    s_add_u32 s51, s51, 4096
    v_lshlrev_b32 v3, 3, v1
    s_waitcnt lgkmcnt(12)
    v_pk_add_f32 v[16:17], v[16:17], v[36:37]
    v_pk_add_f32 v[40:41], v[40:41], v[44:45]
    v_pk_add_f32 v[18:19], v[18:19], v[38:39]
    v_pk_add_f32 v[42:43], v[42:43], v[46:47]
    v_pk_add_f32 v[16:17], v[16:17], v[40:41]
    v_pk_add_f32 v[18:19], v[18:19], v[42:43]
    v_cvt_pk_bf16_f32 v96, v16, v17
    v_cvt_pk_bf16_f32 v97, v18, v19
    s_waitcnt lgkmcnt(9)
    v_pk_add_f32 v[20:21], v[20:21], v[48:49]
    v_pk_add_f32 v[52:53], v[52:53], v[56:57]
    v_pk_add_f32 v[22:23], v[22:23], v[50:51]
    v_pk_add_f32 v[54:55], v[54:55], v[58:59]
    v_pk_add_f32 v[20:21], v[20:21], v[52:53]
    v_pk_add_f32 v[22:23], v[22:23], v[54:55]
    v_cvt_pk_bf16_f32 v98, v20, v21
    v_cvt_pk_bf16_f32 v99, v22, v23
    buffer_store_dwordx4 v[96:99], v10, s[24:27], s52 offen offset:0 sc1
    s_waitcnt lgkmcnt(6)
    v_pk_add_f32 v[24:25], v[24:25], v[60:61]
    v_pk_add_f32 v[64:65], v[64:65], v[68:69]
    v_pk_add_f32 v[26:27], v[26:27], v[62:63]
    v_pk_add_f32 v[66:67], v[66:67], v[70:71]
    v_pk_add_f32 v[24:25], v[24:25], v[64:65]
    v_pk_add_f32 v[26:27], v[26:27], v[66:67]
    v_cvt_pk_bf16_f32 v100, v24, v25
    v_cvt_pk_bf16_f32 v101, v26, v27
    s_waitcnt lgkmcnt(3)
    v_pk_add_f32 v[28:29], v[28:29], v[72:73]
    v_pk_add_f32 v[76:77], v[76:77], v[80:81]
    v_pk_add_f32 v[30:31], v[30:31], v[74:75]
    v_pk_add_f32 v[78:79], v[78:79], v[82:83]
    v_pk_add_f32 v[28:29], v[28:29], v[76:77]
    v_pk_add_f32 v[30:31], v[30:31], v[78:79]
    v_cvt_pk_bf16_f32 v102, v28, v29
    v_cvt_pk_bf16_f32 v103, v30, v31
    buffer_store_dwordx4 v[100:103], v10, s[24:27], s52 offen offset:1024 sc1
    s_waitcnt lgkmcnt(0)
    v_pk_add_f32 v[32:33], v[32:33], v[84:85]
    v_pk_add_f32 v[88:89], v[88:89], v[92:93]
    v_pk_add_f32 v[34:35], v[34:35], v[86:87]
    v_pk_add_f32 v[90:91], v[90:91], v[94:95]
    v_pk_add_f32 v[32:33], v[32:33], v[88:89]
    v_pk_add_f32 v[34:35], v[34:35], v[90:91]
    v_cvt_pk_bf16_f32 v104, v32, v33
    v_cvt_pk_bf16_f32 v105, v34, v35
    buffer_store_dwordx2 v[104:105], v3, s[24:27], s51 offen sc1
    s_mov_b32 s58, s89
    s_branch L_pub
L_x:
    s_sub_u32 s50, s46, 24
    s_lshr_b32 s51, s50, 2
    s_lshl_b32 s47, s45, 1
    s_add_u32 s47, s47, s51
    s_and_b32 s48, s50, 3
    s_mul_i32 s91, s48, 5
    s_lshr_b32 s91, s91, 1
    s_mul_i32 s51, s51, 5
    s_add_u32 s91, s91, s51
    s_add_u32 s91, s91, s45
    s_cmp_ge_u32 s91, 10
    s_cselect_b32 s51, 10, 0
    s_sub_u32 s91, s91, s51
    s_cmp_ge_u32 s91, 10
    s_cselect_b32 s51, 10, 0
    s_sub_u32 s91, s91, s51
    s_movk_i32 s53, 1280
    v_lshrrev_b32 v11, 3, v1
    s_lshl_b32 s50, s44, 5
    v_add_u32 v11, s50, v11
    v_and_b32 v12, 7, v1
    v_lshrrev_b32 v13, 4, v1
    v_add_u32 v14, 0, v13
    v_and_b32 v14, 7, v14
    v_xor_b32 v14, v14, v12
    v_add_u32 v15, 0, v11
    v_mul_u32_u24 v15, s53, v15
    v_lshl_add_u32 v2, v14, 4, v15
    v_add_u32 v14, 4, v13
    v_and_b32 v14, 7, v14
    v_xor_b32 v14, v14, v12
    v_add_u32 v15, 8, v11
    v_mul_u32_u24 v15, s53, v15
    v_lshl_add_u32 v3, v14, 4, v15
    v_subrev_u32 v3, 1024, v3
    v_add_u32 v14, 8, v13
    v_and_b32 v14, 7, v14
    v_xor_b32 v14, v14, v12
    v_add_u32 v15, 16, v11
    v_mul_u32_u24 v15, s53, v15
    v_lshl_add_u32 v4, v14, 4, v15
    v_subrev_u32 v4, 2048, v4
    v_add_u32 v14, 12, v13
    v_and_b32 v14, 7, v14
    v_xor_b32 v14, v14, v12
    v_add_u32 v15, 24, v11
    v_mul_u32_u24 v15, s53, v15
    v_lshl_add_u32 v5, v14, 4, v15
    v_subrev_u32 v5, 3072, v5
    s_movk_i32 s54, 3277
    s_lshl_b32 s50, s44, 4
    v_add_u32 v12, 0, v1
    v_mul_u32_u24 v13, s54, v12
    v_lshrrev_b32 v13, 16, v13
    v_mul_u32_u24 v14, 20, v13
    v_sub_u32 v12, v12, v14
    v_lshrrev_b32 v14, 2, v13
    v_and_b32 v14, 2, v14
    v_xor_b32 v12, v12, v14
    v_add_u32 v13, s50, v13
    v_mul_u32_u24 v13, s53, v13
    v_lshl_add_u32 v6, v12, 4, v13
    v_add_u32 v12, 64, v1
    v_mul_u32_u24 v13, s54, v12
    v_lshrrev_b32 v13, 16, v13
    v_mul_u32_u24 v14, 20, v13
    v_sub_u32 v12, v12, v14
    v_lshrrev_b32 v14, 2, v13
    v_and_b32 v14, 2, v14
    v_xor_b32 v12, v12, v14
    v_add_u32 v13, s50, v13
    v_mul_u32_u24 v13, s53, v13
    v_lshl_add_u32 v7, v12, 4, v13
    v_subrev_u32 v7, 1024, v7
    v_add_u32 v12, 128, v1
    v_mul_u32_u24 v13, s54, v12
    v_lshrrev_b32 v13, 16, v13
    v_mul_u32_u24 v14, 20, v13
    v_sub_u32 v12, v12, v14
    v_lshrrev_b32 v14, 2, v13
    v_and_b32 v14, 2, v14
    v_xor_b32 v12, v12, v14
    v_add_u32 v13, s50, v13
    v_mul_u32_u24 v13, s53, v13
    v_lshl_add_u32 v8, v12, 4, v13
    v_subrev_u32 v8, 2048, v8
    v_add_u32 v12, 192, v1
    v_mul_u32_u24 v13, s54, v12
    v_lshrrev_b32 v13, 16, v13
    v_mul_u32_u24 v14, 20, v13
    v_sub_u32 v12, v12, v14
    v_lshrrev_b32 v14, 2, v13
    v_and_b32 v14, 2, v14
    v_xor_b32 v12, v12, v14
    v_add_u32 v13, s50, v13
    v_mul_u32_u24 v13, s53, v13
    v_lshl_add_u32 v9, v12, 4, v13
    v_subrev_u32 v9, 3072, v9
    v_add_u32 v12, 256, v1
    v_mul_u32_u24 v13, s54, v12
    v_lshrrev_b32 v13, 16, v13
    v_mul_u32_u24 v14, 20, v13
    v_sub_u32 v12, v12, v14
    v_lshrrev_b32 v14, 2, v13
    v_and_b32 v14, 2, v14
    v_xor_b32 v12, v12, v14
    v_add_u32 v13, s50, v13
    v_mul_u32_u24 v13, s53, v13
    v_lshl_add_u32 v11, v12, 4, v13
    s_mul_i32 s55, s47, 163840
    s_mul_i32 s56, s48, 320
    s_lshl_b32 s57, s44, 12
    s_mul_i32 s58, s44, 5120
    s_add_u32 s58, s58, 16384
    s_mov_b32 s50, s91
    s_lshl_b32 s86, s50, 7
    s_add_u32 s86, s86, s55
    s_add_u32 s87, s55, 1280
    s_mul_i32 s88, s50, 81920
    s_add_u32 s88, s88, s56
    s_add_u32 s90, s56, 819200
    s_waitcnt lgkmcnt(0)
    s_mov_b32 s28, s4
    s_and_b32 s29, s5, 0xffff
    s_mov_b32 s30, 0x280000
    s_mov_b32 s31, 0x20000
    s_mov_b32 s32, s12
    s_and_b32 s33, s13, 0xffff
    s_mov_b32 s34, 0xc8000
    s_mov_b32 s35, 0x20000
    s_add_u32 m0, s57, 0
    s_nop 0
    buffer_load_dwordx4 v2, s[28:31], s86 offen offset:0 lds
    s_add_u32 m0, s57, 0
    s_nop 0
    buffer_load_dwordx4 v3, s[28:31], s86 offen offset:1024 lds
    s_add_u32 m0, s57, 0
    s_nop 0
    buffer_load_dwordx4 v4, s[28:31], s86 offen offset:2048 lds
    s_add_u32 m0, s57, 0
    s_nop 0
    buffer_load_dwordx4 v5, s[28:31], s86 offen offset:3072 lds
    s_add_u32 m0, s58, 0
    s_nop 0
    buffer_load_dwordx4 v6, s[32:35], s88 offen offset:0 lds
    s_add_u32 m0, s58, 0
    s_nop 0
    buffer_load_dwordx4 v7, s[32:35], s88 offen offset:1024 lds
    s_add_u32 m0, s58, 0
    s_nop 0
    buffer_load_dwordx4 v8, s[32:35], s88 offen offset:2048 lds
    s_add_u32 m0, s58, 0
    s_nop 0
    buffer_load_dwordx4 v9, s[32:35], s88 offen offset:3072 lds
    s_add_u32 m0, s58, 4096
    s_nop 0
    buffer_load_dwordx4 v11, s[32:35], s88 offen offset:0 lds
    s_add_u32 s86, s86, 128
    s_cmp_eq_u32 s86, s87
    s_cselect_b32 s86, s55, s86
    s_add_u32 m0, s57, 36864
    s_nop 0
    buffer_load_dwordx4 v2, s[28:31], s86 offen offset:0 lds
    s_add_u32 m0, s57, 36864
    s_nop 0
    buffer_load_dwordx4 v3, s[28:31], s86 offen offset:1024 lds
    s_add_u32 m0, s57, 36864
    s_nop 0
    buffer_load_dwordx4 v4, s[28:31], s86 offen offset:2048 lds
    s_add_u32 m0, s57, 36864
    s_nop 0
    buffer_load_dwordx4 v5, s[28:31], s86 offen offset:3072 lds
    s_add_u32 s88, s88, 81920
    s_cmp_eq_u32 s88, s90
    s_cselect_b32 s88, s56, s88
    s_add_u32 m0, s58, 36864
    s_nop 0
    buffer_load_dwordx4 v6, s[32:35], s88 offen offset:0 lds
    s_add_u32 m0, s58, 36864
    s_nop 0
    buffer_load_dwordx4 v7, s[32:35], s88 offen offset:1024 lds
    s_add_u32 m0, s58, 36864
    s_nop 0
    buffer_load_dwordx4 v8, s[32:35], s88 offen offset:2048 lds
    s_add_u32 m0, s58, 36864
    s_nop 0
    buffer_load_dwordx4 v9, s[32:35], s88 offen offset:3072 lds
    s_add_u32 m0, s58, 40960
    s_nop 0
    buffer_load_dwordx4 v11, s[32:35], s88 offen offset:0 lds
    s_mov_b32 s24, s20
    s_and_b32 s25, s21, 0xffff
    s_mov_b32 s26, 0x800000
    s_mov_b32 s27, 0x20000
    s_add_u32 s22, s20, 0x700000
    s_addc_u32 s23, s21, 0
    s_load_dword s80, s[22:23], 0
    s_lshr_b32 s81, s45, 1
    s_lshl_b32 s81, s81, 2
    s_lshr_b32 s50, s46, 3
    s_add_u32 s81, s81, s50
    s_and_b32 s49, s45, 1
    s_lshl_b32 s49, s49, 3
    s_and_b32 s50, s46, 7
    s_add_u32 s49, s49, s50
    s_lshl_b32 s60, s81, 9
    s_add_u32 s60, s60, 0x718000
    s_mul_i32 s61, s49, 3
    s_lshr_b32 s61, s61, 1
    s_lshl_b32 s61, s61, 10
    s_add_u32 s61, s61, 0x710000
    v_and_b32 v12, 15, v1
    v_lshrrev_b32 v13, 4, v1
    v_lshrrev_b32 v14, 1, v12
    v_xor_b32 v14, v14, v13
    s_lshr_b32 s50, s44, 1
    s_lshl_b32 s50, s50, 13
    v_lshlrev_b32 v12, 7, v12
    v_lshl_add_u32 v12, v14, 4, v12
    v_add_u32 v176, s50, v12
    v_xor_b32 v177, 64, v176
    v_add_u32 v178, 73728, v176
    v_add_u32 v179, 73728, v177
    v_lshlrev_b32 v12, 3, v13
    v_bfe_u32 v14, v1, 2, 2
    v_add_u32 v12, v12, v14
    s_movk_i32 s50, 320
    v_mul_u32_u24 v12, s50, v12
    v_and_b32 v14, 3, v1
    v_lshl_add_u32 v12, v14, 3, v12
    s_and_b32 s50, s44, 1
    s_mul_i32 s51, s50, 160
    s_add_u32 s51, s51, 16384
    v_add_u32 v12, s51, v12
    v_and_b32 v13, 1, v13
    v_lshlrev_b32 v13, 5, v13
    s_lshl_b32 s50, s50, 1
    s_sub_u32 s50, 1, s50
    v_mul_lo_u32 v13, v13, s50
    v_add_u32 v180, v12, v13
    v_sub_u32 v181, v12, v13
    v_add_u32 v182, 73728, v180
    v_add_u32 v183, 73728, v181
    s_waitcnt lgkmcnt(0)
    s_mul_i32 s80, s80, 0x9E3779B1
    s_add_u32 s80, s80, 0x7F4A7C15
    s_xor_b32 s62, s80, 0x5bd1e995
    s_mul_i32 s62, s62, 0x85EBCA6B
    s_waitcnt vmcnt(9)
    s_barrier
    ds_read_b128 v[96:99], v176 offset:0
    ds_read_b64_tr_b16 v[112:113], v180 offset:0
    ds_read_b64_tr_b16 v[114:115], v180 offset:1280
    ds_read_b128 v[100:103], v176 offset:2048
    ds_read_b64_tr_b16 v[116:117], v181 offset:32
    ds_read_b64_tr_b16 v[118:119], v181 offset:1312
    ds_read_b128 v[104:107], v176 offset:4096
    ds_read_b64_tr_b16 v[120:121], v180 offset:64
    ds_read_b64_tr_b16 v[122:123], v180 offset:1344
    ds_read_b128 v[108:111], v176 offset:6144
    ds_read_b64_tr_b16 v[124:125], v181 offset:96
    ds_read_b64_tr_b16 v[126:127], v181 offset:1376
    ds_read_b64_tr_b16 v[128:129], v180 offset:128
    ds_read_b64_tr_b16 v[130:131], v180 offset:1408
    s_waitcnt lgkmcnt(0)
    v_mfma_f32_16x16x32_bf16 v[16:19], v[112:115], v[96:99], 0
    v_mfma_f32_16x16x32_bf16 v[20:23], v[112:115], v[100:103], 0
    ds_read_b128 v[132:135], v177 offset:0
    v_mfma_f32_16x16x32_bf16 v[24:27], v[112:115], v[104:107], 0
    ds_read_b64_tr_b16 v[148:149], v180 offset:10240
    v_mfma_f32_16x16x32_bf16 v[28:31], v[112:115], v[108:111], 0
    ds_read_b64_tr_b16 v[150:151], v180 offset:11520
    s_add_u32 s86, s86, 128
    s_cmp_eq_u32 s86, s87
    s_cselect_b32 s86, s55, s86
    s_add_u32 m0, s57, 73728
    s_nop 0
    buffer_load_dwordx4 v2, s[28:31], s86 offen offset:0 lds
    v_mfma_f32_16x16x32_bf16 v[32:35], v[116:119], v[96:99], 0
    ds_read_b128 v[136:139], v177 offset:2048
    v_mfma_f32_16x16x32_bf16 v[36:39], v[116:119], v[100:103], 0
    ds_read_b64_tr_b16 v[152:153], v181 offset:10272
    v_mfma_f32_16x16x32_bf16 v[40:43], v[116:119], v[104:107], 0
    ds_read_b64_tr_b16 v[154:155], v181 offset:11552
    v_mfma_f32_16x16x32_bf16 v[44:47], v[116:119], v[108:111], 0
    ds_read_b128 v[140:143], v177 offset:4096
    s_add_u32 m0, s57, 73728
    s_nop 0
    buffer_load_dwordx4 v3, s[28:31], s86 offen offset:1024 lds
    v_mfma_f32_16x16x32_bf16 v[48:51], v[120:123], v[96:99], 0
    ds_read_b64_tr_b16 v[156:157], v180 offset:10304
    v_mfma_f32_16x16x32_bf16 v[52:55], v[120:123], v[100:103], 0
    ds_read_b64_tr_b16 v[158:159], v180 offset:11584
    v_mfma_f32_16x16x32_bf16 v[56:59], v[120:123], v[104:107], 0
    ds_read_b128 v[144:147], v177 offset:6144
    v_mfma_f32_16x16x32_bf16 v[60:63], v[120:123], v[108:111], 0
    ds_read_b64_tr_b16 v[160:161], v181 offset:10336
    s_add_u32 m0, s57, 73728
    s_nop 0
    buffer_load_dwordx4 v4, s[28:31], s86 offen offset:2048 lds
    v_mfma_f32_16x16x32_bf16 v[64:67], v[124:127], v[96:99], 0
    ds_read_b64_tr_b16 v[162:163], v181 offset:11616
    v_mfma_f32_16x16x32_bf16 v[68:71], v[124:127], v[100:103], 0
    ds_read_b64_tr_b16 v[164:165], v180 offset:10368
    v_mfma_f32_16x16x32_bf16 v[72:75], v[124:127], v[104:107], 0
    ds_read_b64_tr_b16 v[166:167], v180 offset:11648
    v_mfma_f32_16x16x32_bf16 v[76:79], v[124:127], v[108:111], 0
    s_add_u32 m0, s57, 73728
    s_nop 0
    buffer_load_dwordx4 v5, s[28:31], s86 offen offset:3072 lds
    v_mfma_f32_16x16x32_bf16 v[80:83], v[128:131], v[96:99], 0
    v_mfma_f32_16x16x32_bf16 v[84:87], v[128:131], v[100:103], 0
    v_mfma_f32_16x16x32_bf16 v[88:91], v[128:131], v[104:107], 0
    v_mfma_f32_16x16x32_bf16 v[92:95], v[128:131], v[108:111], 0
    s_add_u32 s88, s88, 81920
    s_cmp_eq_u32 s88, s90
    s_cselect_b32 s88, s56, s88
    s_add_u32 m0, s58, 73728
    s_nop 0
    buffer_load_dwordx4 v6, s[32:35], s88 offen offset:0 lds
    s_waitcnt lgkmcnt(0)
    v_mfma_f32_16x16x32_bf16 v[16:19], v[148:151], v[132:135], v[16:19]
    v_mfma_f32_16x16x32_bf16 v[20:23], v[148:151], v[136:139], v[20:23]
    s_waitcnt vmcnt(5)
    s_barrier
    ds_read_b128 v[96:99], v176 offset:36864
    v_mfma_f32_16x16x32_bf16 v[24:27], v[148:151], v[140:143], v[24:27]
    ds_read_b64_tr_b16 v[112:113], v180 offset:36864
    v_mfma_f32_16x16x32_bf16 v[28:31], v[148:151], v[144:147], v[28:31]
    ds_read_b64_tr_b16 v[114:115], v180 offset:38144
    s_add_u32 m0, s58, 73728
    s_nop 0
    buffer_load_dwordx4 v7, s[32:35], s88 offen offset:1024 lds
    v_mfma_f32_16x16x32_bf16 v[32:35], v[152:155], v[132:135], v[32:35]
    ds_read_b128 v[100:103], v176 offset:38912
    v_mfma_f32_16x16x32_bf16 v[36:39], v[152:155], v[136:139], v[36:39]
    ds_read_b64_tr_b16 v[116:117], v181 offset:36896
    v_mfma_f32_16x16x32_bf16 v[40:43], v[152:155], v[140:143], v[40:43]
    ds_read_b64_tr_b16 v[118:119], v181 offset:38176
    v_mfma_f32_16x16x32_bf16 v[44:47], v[152:155], v[144:147], v[44:47]
    ds_read_b128 v[104:107], v176 offset:40960
    s_add_u32 m0, s58, 73728
    s_nop 0
    buffer_load_dwordx4 v8, s[32:35], s88 offen offset:2048 lds
    v_mfma_f32_16x16x32_bf16 v[48:51], v[156:159], v[132:135], v[48:51]
    ds_read_b64_tr_b16 v[120:121], v180 offset:36928
    v_mfma_f32_16x16x32_bf16 v[52:55], v[156:159], v[136:139], v[52:55]
    ds_read_b64_tr_b16 v[122:123], v180 offset:38208
    v_mfma_f32_16x16x32_bf16 v[56:59], v[156:159], v[140:143], v[56:59]
    ds_read_b128 v[108:111], v176 offset:43008
    v_mfma_f32_16x16x32_bf16 v[60:63], v[156:159], v[144:147], v[60:63]
    ds_read_b64_tr_b16 v[124:125], v181 offset:36960
    s_add_u32 m0, s58, 73728
    s_nop 0
    buffer_load_dwordx4 v9, s[32:35], s88 offen offset:3072 lds
    v_mfma_f32_16x16x32_bf16 v[64:67], v[160:163], v[132:135], v[64:67]
    ds_read_b64_tr_b16 v[126:127], v181 offset:38240
    v_mfma_f32_16x16x32_bf16 v[68:71], v[160:163], v[136:139], v[68:71]
    ds_read_b64_tr_b16 v[128:129], v180 offset:36992
    v_mfma_f32_16x16x32_bf16 v[72:75], v[160:163], v[140:143], v[72:75]
    ds_read_b64_tr_b16 v[130:131], v180 offset:38272
    v_mfma_f32_16x16x32_bf16 v[76:79], v[160:163], v[144:147], v[76:79]
    s_add_u32 m0, s58, 77824
    s_nop 0
    buffer_load_dwordx4 v11, s[32:35], s88 offen offset:0 lds
    v_mfma_f32_16x16x32_bf16 v[80:83], v[164:167], v[132:135], v[80:83]
    v_mfma_f32_16x16x32_bf16 v[84:87], v[164:167], v[136:139], v[84:87]
    v_mfma_f32_16x16x32_bf16 v[88:91], v[164:167], v[140:143], v[88:91]
    v_mfma_f32_16x16x32_bf16 v[92:95], v[164:167], v[144:147], v[92:95]
    s_add_u32 s86, s86, 128
    s_cmp_eq_u32 s86, s87
    s_cselect_b32 s86, s55, s86
    s_add_u32 m0, s57, 110592
    s_nop 0
    buffer_load_dwordx4 v2, s[28:31], s86 offen offset:0 lds
    s_waitcnt lgkmcnt(0)
    v_mfma_f32_16x16x32_bf16 v[16:19], v[112:115], v[96:99], v[16:19]
    v_mfma_f32_16x16x32_bf16 v[20:23], v[112:115], v[100:103], v[20:23]
    ds_read_b128 v[132:135], v177 offset:36864
    v_mfma_f32_16x16x32_bf16 v[24:27], v[112:115], v[104:107], v[24:27]
    ds_read_b64_tr_b16 v[148:149], v180 offset:47104
    v_mfma_f32_16x16x32_bf16 v[28:31], v[112:115], v[108:111], v[28:31]
    ds_read_b64_tr_b16 v[150:151], v180 offset:48384
    s_add_u32 m0, s57, 110592
    s_nop 0
    buffer_load_dwordx4 v3, s[28:31], s86 offen offset:1024 lds
    v_mfma_f32_16x16x32_bf16 v[32:35], v[116:119], v[96:99], v[32:35]
    ds_read_b128 v[136:139], v177 offset:38912
    v_mfma_f32_16x16x32_bf16 v[36:39], v[116:119], v[100:103], v[36:39]
    ds_read_b64_tr_b16 v[152:153], v181 offset:47136
    v_mfma_f32_16x16x32_bf16 v[40:43], v[116:119], v[104:107], v[40:43]
    ds_read_b64_tr_b16 v[154:155], v181 offset:48416
    v_mfma_f32_16x16x32_bf16 v[44:47], v[116:119], v[108:111], v[44:47]
    ds_read_b128 v[140:143], v177 offset:40960
    s_add_u32 m0, s57, 110592
    s_nop 0
    buffer_load_dwordx4 v4, s[28:31], s86 offen offset:2048 lds
    v_mfma_f32_16x16x32_bf16 v[48:51], v[120:123], v[96:99], v[48:51]
    ds_read_b64_tr_b16 v[156:157], v180 offset:47168
    v_mfma_f32_16x16x32_bf16 v[52:55], v[120:123], v[100:103], v[52:55]
    ds_read_b64_tr_b16 v[158:159], v180 offset:48448
    v_mfma_f32_16x16x32_bf16 v[56:59], v[120:123], v[104:107], v[56:59]
    ds_read_b128 v[144:147], v177 offset:43008
    v_mfma_f32_16x16x32_bf16 v[60:63], v[120:123], v[108:111], v[60:63]
    ds_read_b64_tr_b16 v[160:161], v181 offset:47200
    s_add_u32 m0, s57, 110592
    s_nop 0
    buffer_load_dwordx4 v5, s[28:31], s86 offen offset:3072 lds
    v_mfma_f32_16x16x32_bf16 v[64:67], v[124:127], v[96:99], v[64:67]
    ds_read_b64_tr_b16 v[162:163], v181 offset:48480
    v_mfma_f32_16x16x32_bf16 v[68:71], v[124:127], v[100:103], v[68:71]
    ds_read_b64_tr_b16 v[164:165], v180 offset:47232
    v_mfma_f32_16x16x32_bf16 v[72:75], v[124:127], v[104:107], v[72:75]
    ds_read_b64_tr_b16 v[166:167], v180 offset:48512
    v_mfma_f32_16x16x32_bf16 v[76:79], v[124:127], v[108:111], v[76:79]
    s_add_u32 s88, s88, 81920
    s_cmp_eq_u32 s88, s90
    s_cselect_b32 s88, s56, s88
    s_add_u32 m0, s58, 110592
    s_nop 0
    buffer_load_dwordx4 v6, s[32:35], s88 offen offset:0 lds
    v_mfma_f32_16x16x32_bf16 v[80:83], v[128:131], v[96:99], v[80:83]
    v_mfma_f32_16x16x32_bf16 v[84:87], v[128:131], v[100:103], v[84:87]
    v_mfma_f32_16x16x32_bf16 v[88:91], v[128:131], v[104:107], v[88:91]
    v_mfma_f32_16x16x32_bf16 v[92:95], v[128:131], v[108:111], v[92:95]
    s_add_u32 m0, s58, 110592
    s_nop 0
    buffer_load_dwordx4 v7, s[32:35], s88 offen offset:1024 lds
    s_waitcnt lgkmcnt(0)
    v_mfma_f32_16x16x32_bf16 v[16:19], v[148:151], v[132:135], v[16:19]
    v_mfma_f32_16x16x32_bf16 v[20:23], v[148:151], v[136:139], v[20:23]
    s_waitcnt vmcnt(6)
    s_barrier
    ds_read_b128 v[96:99], v178 offset:0
    v_mfma_f32_16x16x32_bf16 v[24:27], v[148:151], v[140:143], v[24:27]
    ds_read_b64_tr_b16 v[112:113], v182 offset:0
    v_mfma_f32_16x16x32_bf16 v[28:31], v[148:151], v[144:147], v[28:31]
    ds_read_b64_tr_b16 v[114:115], v182 offset:1280
    s_add_u32 m0, s58, 110592
    s_nop 0
    buffer_load_dwordx4 v8, s[32:35], s88 offen offset:2048 lds
    v_mfma_f32_16x16x32_bf16 v[32:35], v[152:155], v[132:135], v[32:35]
    ds_read_b128 v[100:103], v178 offset:2048
    v_mfma_f32_16x16x32_bf16 v[36:39], v[152:155], v[136:139], v[36:39]
    ds_read_b64_tr_b16 v[116:117], v183 offset:32
    v_mfma_f32_16x16x32_bf16 v[40:43], v[152:155], v[140:143], v[40:43]
    ds_read_b64_tr_b16 v[118:119], v183 offset:1312
    v_mfma_f32_16x16x32_bf16 v[44:47], v[152:155], v[144:147], v[44:47]
    ds_read_b128 v[104:107], v178 offset:4096
    s_add_u32 m0, s58, 110592
    s_nop 0
    buffer_load_dwordx4 v9, s[32:35], s88 offen offset:3072 lds
    v_mfma_f32_16x16x32_bf16 v[48:51], v[156:159], v[132:135], v[48:51]
    ds_read_b64_tr_b16 v[120:121], v182 offset:64
    v_mfma_f32_16x16x32_bf16 v[52:55], v[156:159], v[136:139], v[52:55]
    ds_read_b64_tr_b16 v[122:123], v182 offset:1344
    v_mfma_f32_16x16x32_bf16 v[56:59], v[156:159], v[140:143], v[56:59]
    ds_read_b128 v[108:111], v178 offset:6144
    v_mfma_f32_16x16x32_bf16 v[60:63], v[156:159], v[144:147], v[60:63]
    ds_read_b64_tr_b16 v[124:125], v183 offset:96
    s_add_u32 m0, s58, 114688
    s_nop 0
    buffer_load_dwordx4 v11, s[32:35], s88 offen offset:0 lds
    v_mfma_f32_16x16x32_bf16 v[64:67], v[160:163], v[132:135], v[64:67]
    ds_read_b64_tr_b16 v[126:127], v183 offset:1376
    v_mfma_f32_16x16x32_bf16 v[68:71], v[160:163], v[136:139], v[68:71]
    ds_read_b64_tr_b16 v[128:129], v182 offset:128
    v_mfma_f32_16x16x32_bf16 v[72:75], v[160:163], v[140:143], v[72:75]
    ds_read_b64_tr_b16 v[130:131], v182 offset:1408
    v_mfma_f32_16x16x32_bf16 v[76:79], v[160:163], v[144:147], v[76:79]
    s_add_u32 s86, s86, 128
    s_cmp_eq_u32 s86, s87
    s_cselect_b32 s86, s55, s86
    s_add_u32 m0, s57, 0
    s_nop 0
    buffer_load_dwordx4 v2, s[28:31], s86 offen offset:0 lds
    v_mfma_f32_16x16x32_bf16 v[80:83], v[164:167], v[132:135], v[80:83]
    v_mfma_f32_16x16x32_bf16 v[84:87], v[164:167], v[136:139], v[84:87]
    v_mfma_f32_16x16x32_bf16 v[88:91], v[164:167], v[140:143], v[88:91]
    v_mfma_f32_16x16x32_bf16 v[92:95], v[164:167], v[144:147], v[92:95]
    s_add_u32 m0, s57, 0
    s_nop 0
    buffer_load_dwordx4 v3, s[28:31], s86 offen offset:1024 lds
    s_waitcnt lgkmcnt(0)
    v_mfma_f32_16x16x32_bf16 v[16:19], v[112:115], v[96:99], v[16:19]
    v_mfma_f32_16x16x32_bf16 v[20:23], v[112:115], v[100:103], v[20:23]
    ds_read_b128 v[132:135], v179 offset:0
    v_mfma_f32_16x16x32_bf16 v[24:27], v[112:115], v[104:107], v[24:27]
    ds_read_b64_tr_b16 v[148:149], v182 offset:10240
    v_mfma_f32_16x16x32_bf16 v[28:31], v[112:115], v[108:111], v[28:31]
    ds_read_b64_tr_b16 v[150:151], v182 offset:11520
    s_add_u32 m0, s57, 0
    s_nop 0
    buffer_load_dwordx4 v4, s[28:31], s86 offen offset:2048 lds
    v_mfma_f32_16x16x32_bf16 v[32:35], v[116:119], v[96:99], v[32:35]
    ds_read_b128 v[136:139], v179 offset:2048
    v_mfma_f32_16x16x32_bf16 v[36:39], v[116:119], v[100:103], v[36:39]
    ds_read_b64_tr_b16 v[152:153], v183 offset:10272
    v_mfma_f32_16x16x32_bf16 v[40:43], v[116:119], v[104:107], v[40:43]
    ds_read_b64_tr_b16 v[154:155], v183 offset:11552
    v_mfma_f32_16x16x32_bf16 v[44:47], v[116:119], v[108:111], v[44:47]
    ds_read_b128 v[140:143], v179 offset:4096
    s_add_u32 m0, s57, 0
    s_nop 0
    buffer_load_dwordx4 v5, s[28:31], s86 offen offset:3072 lds
    v_mfma_f32_16x16x32_bf16 v[48:51], v[120:123], v[96:99], v[48:51]
    ds_read_b64_tr_b16 v[156:157], v182 offset:10304
    v_mfma_f32_16x16x32_bf16 v[52:55], v[120:123], v[100:103], v[52:55]
    ds_read_b64_tr_b16 v[158:159], v182 offset:11584
    v_mfma_f32_16x16x32_bf16 v[56:59], v[120:123], v[104:107], v[56:59]
    ds_read_b128 v[144:147], v179 offset:6144
    v_mfma_f32_16x16x32_bf16 v[60:63], v[120:123], v[108:111], v[60:63]
    ds_read_b64_tr_b16 v[160:161], v183 offset:10336
    s_add_u32 s88, s88, 81920
    s_cmp_eq_u32 s88, s90
    s_cselect_b32 s88, s56, s88
    s_add_u32 m0, s58, 0
    s_nop 0
    buffer_load_dwordx4 v6, s[32:35], s88 offen offset:0 lds
    v_mfma_f32_16x16x32_bf16 v[64:67], v[124:127], v[96:99], v[64:67]
    ds_read_b64_tr_b16 v[162:163], v183 offset:11616
    v_mfma_f32_16x16x32_bf16 v[68:71], v[124:127], v[100:103], v[68:71]
    ds_read_b64_tr_b16 v[164:165], v182 offset:10368
    v_mfma_f32_16x16x32_bf16 v[72:75], v[124:127], v[104:107], v[72:75]
    ds_read_b64_tr_b16 v[166:167], v182 offset:11648
    v_mfma_f32_16x16x32_bf16 v[76:79], v[124:127], v[108:111], v[76:79]
    s_add_u32 m0, s58, 0
    s_nop 0
    buffer_load_dwordx4 v7, s[32:35], s88 offen offset:1024 lds
    v_mfma_f32_16x16x32_bf16 v[80:83], v[128:131], v[96:99], v[80:83]
    v_mfma_f32_16x16x32_bf16 v[84:87], v[128:131], v[100:103], v[84:87]
    v_mfma_f32_16x16x32_bf16 v[88:91], v[128:131], v[104:107], v[88:91]
    v_mfma_f32_16x16x32_bf16 v[92:95], v[128:131], v[108:111], v[92:95]
    s_add_u32 m0, s58, 0
    s_nop 0
    buffer_load_dwordx4 v8, s[32:35], s88 offen offset:2048 lds
    s_waitcnt lgkmcnt(0)
    v_mfma_f32_16x16x32_bf16 v[16:19], v[148:151], v[132:135], v[16:19]
    v_mfma_f32_16x16x32_bf16 v[20:23], v[148:151], v[136:139], v[20:23]
    s_waitcnt vmcnt(7)
    s_barrier
    ds_read_b128 v[96:99], v178 offset:36864
    v_mfma_f32_16x16x32_bf16 v[24:27], v[148:151], v[140:143], v[24:27]
    ds_read_b64_tr_b16 v[112:113], v182 offset:36864
    v_mfma_f32_16x16x32_bf16 v[28:31], v[148:151], v[144:147], v[28:31]
    ds_read_b64_tr_b16 v[114:115], v182 offset:38144
    s_add_u32 m0, s58, 0
    s_nop 0
    buffer_load_dwordx4 v9, s[32:35], s88 offen offset:3072 lds
    v_mfma_f32_16x16x32_bf16 v[32:35], v[152:155], v[132:135], v[32:35]
    ds_read_b128 v[100:103], v178 offset:38912
    v_mfma_f32_16x16x32_bf16 v[36:39], v[152:155], v[136:139], v[36:39]
    ds_read_b64_tr_b16 v[116:117], v183 offset:36896
    v_mfma_f32_16x16x32_bf16 v[40:43], v[152:155], v[140:143], v[40:43]
    ds_read_b64_tr_b16 v[118:119], v183 offset:38176
    v_mfma_f32_16x16x32_bf16 v[44:47], v[152:155], v[144:147], v[44:47]
    ds_read_b128 v[104:107], v178 offset:40960
    s_add_u32 m0, s58, 4096
    s_nop 0
    buffer_load_dwordx4 v11, s[32:35], s88 offen offset:0 lds
    v_mfma_f32_16x16x32_bf16 v[48:51], v[156:159], v[132:135], v[48:51]
    ds_read_b64_tr_b16 v[120:121], v182 offset:36928
    v_mfma_f32_16x16x32_bf16 v[52:55], v[156:159], v[136:139], v[52:55]
    ds_read_b64_tr_b16 v[122:123], v182 offset:38208
    v_mfma_f32_16x16x32_bf16 v[56:59], v[156:159], v[140:143], v[56:59]
    ds_read_b128 v[108:111], v178 offset:43008
    v_mfma_f32_16x16x32_bf16 v[60:63], v[156:159], v[144:147], v[60:63]
    ds_read_b64_tr_b16 v[124:125], v183 offset:36960
    s_add_u32 s86, s86, 128
    s_cmp_eq_u32 s86, s87
    s_cselect_b32 s86, s55, s86
    s_add_u32 m0, s57, 36864
    s_nop 0
    buffer_load_dwordx4 v2, s[28:31], s86 offen offset:0 lds
    v_mfma_f32_16x16x32_bf16 v[64:67], v[160:163], v[132:135], v[64:67]
    ds_read_b64_tr_b16 v[126:127], v183 offset:38240
    v_mfma_f32_16x16x32_bf16 v[68:71], v[160:163], v[136:139], v[68:71]
    ds_read_b64_tr_b16 v[128:129], v182 offset:36992
    v_mfma_f32_16x16x32_bf16 v[72:75], v[160:163], v[140:143], v[72:75]
    ds_read_b64_tr_b16 v[130:131], v182 offset:38272
    v_mfma_f32_16x16x32_bf16 v[76:79], v[160:163], v[144:147], v[76:79]
    s_add_u32 m0, s57, 36864
    s_nop 0
    buffer_load_dwordx4 v3, s[28:31], s86 offen offset:1024 lds
    v_mfma_f32_16x16x32_bf16 v[80:83], v[164:167], v[132:135], v[80:83]
    v_mfma_f32_16x16x32_bf16 v[84:87], v[164:167], v[136:139], v[84:87]
    v_mfma_f32_16x16x32_bf16 v[88:91], v[164:167], v[140:143], v[88:91]
    v_mfma_f32_16x16x32_bf16 v[92:95], v[164:167], v[144:147], v[92:95]
    s_add_u32 m0, s57, 36864
    s_nop 0
    buffer_load_dwordx4 v4, s[28:31], s86 offen offset:2048 lds
    s_waitcnt lgkmcnt(0)
    v_mfma_f32_16x16x32_bf16 v[16:19], v[112:115], v[96:99], v[16:19]
    v_mfma_f32_16x16x32_bf16 v[20:23], v[112:115], v[100:103], v[20:23]
    ds_read_b128 v[132:135], v179 offset:36864
    v_mfma_f32_16x16x32_bf16 v[24:27], v[112:115], v[104:107], v[24:27]
    ds_read_b64_tr_b16 v[148:149], v182 offset:47104
    v_mfma_f32_16x16x32_bf16 v[28:31], v[112:115], v[108:111], v[28:31]
    ds_read_b64_tr_b16 v[150:151], v182 offset:48384
    s_add_u32 m0, s57, 36864
    s_nop 0
    buffer_load_dwordx4 v5, s[28:31], s86 offen offset:3072 lds
    v_mfma_f32_16x16x32_bf16 v[32:35], v[116:119], v[96:99], v[32:35]
    ds_read_b128 v[136:139], v179 offset:38912
    v_mfma_f32_16x16x32_bf16 v[36:39], v[116:119], v[100:103], v[36:39]
    ds_read_b64_tr_b16 v[152:153], v183 offset:47136
    v_mfma_f32_16x16x32_bf16 v[40:43], v[116:119], v[104:107], v[40:43]
    ds_read_b64_tr_b16 v[154:155], v183 offset:48416
    v_mfma_f32_16x16x32_bf16 v[44:47], v[116:119], v[108:111], v[44:47]
    ds_read_b128 v[140:143], v179 offset:40960
    s_add_u32 s88, s88, 81920
    s_cmp_eq_u32 s88, s90
    s_cselect_b32 s88, s56, s88
    s_add_u32 m0, s58, 36864
    s_nop 0
    buffer_load_dwordx4 v6, s[32:35], s88 offen offset:0 lds
    v_mfma_f32_16x16x32_bf16 v[48:51], v[120:123], v[96:99], v[48:51]
    ds_read_b64_tr_b16 v[156:157], v182 offset:47168
    v_mfma_f32_16x16x32_bf16 v[52:55], v[120:123], v[100:103], v[52:55]
    ds_read_b64_tr_b16 v[158:159], v182 offset:48448
    v_mfma_f32_16x16x32_bf16 v[56:59], v[120:123], v[104:107], v[56:59]
    ds_read_b128 v[144:147], v179 offset:43008
    v_mfma_f32_16x16x32_bf16 v[60:63], v[120:123], v[108:111], v[60:63]
    ds_read_b64_tr_b16 v[160:161], v183 offset:47200
    s_add_u32 m0, s58, 36864
    s_nop 0
    buffer_load_dwordx4 v7, s[32:35], s88 offen offset:1024 lds
    v_mfma_f32_16x16x32_bf16 v[64:67], v[124:127], v[96:99], v[64:67]
    ds_read_b64_tr_b16 v[162:163], v183 offset:48480
    v_mfma_f32_16x16x32_bf16 v[68:71], v[124:127], v[100:103], v[68:71]
    ds_read_b64_tr_b16 v[164:165], v182 offset:47232
    v_mfma_f32_16x16x32_bf16 v[72:75], v[124:127], v[104:107], v[72:75]
    ds_read_b64_tr_b16 v[166:167], v182 offset:48512
    v_mfma_f32_16x16x32_bf16 v[76:79], v[124:127], v[108:111], v[76:79]
    s_add_u32 m0, s58, 36864
    s_nop 0
    buffer_load_dwordx4 v8, s[32:35], s88 offen offset:2048 lds
    v_mfma_f32_16x16x32_bf16 v[80:83], v[128:131], v[96:99], v[80:83]
    v_mfma_f32_16x16x32_bf16 v[84:87], v[128:131], v[100:103], v[84:87]
    v_mfma_f32_16x16x32_bf16 v[88:91], v[128:131], v[104:107], v[88:91]
    v_mfma_f32_16x16x32_bf16 v[92:95], v[128:131], v[108:111], v[92:95]
    s_add_u32 m0, s58, 36864
    s_nop 0
    buffer_load_dwordx4 v9, s[32:35], s88 offen offset:3072 lds
    s_waitcnt lgkmcnt(0)
    v_mfma_f32_16x16x32_bf16 v[16:19], v[148:151], v[132:135], v[16:19]
    v_mfma_f32_16x16x32_bf16 v[20:23], v[148:151], v[136:139], v[20:23]
    s_waitcnt vmcnt(8)
    s_barrier
    ds_read_b128 v[96:99], v176 offset:0
    v_mfma_f32_16x16x32_bf16 v[24:27], v[148:151], v[140:143], v[24:27]
    ds_read_b64_tr_b16 v[112:113], v180 offset:0
    v_mfma_f32_16x16x32_bf16 v[28:31], v[148:151], v[144:147], v[28:31]
    ds_read_b64_tr_b16 v[114:115], v180 offset:1280
    s_add_u32 m0, s58, 40960
    s_nop 0
    buffer_load_dwordx4 v11, s[32:35], s88 offen offset:0 lds
    v_mfma_f32_16x16x32_bf16 v[32:35], v[152:155], v[132:135], v[32:35]
    ds_read_b128 v[100:103], v176 offset:2048
    v_mfma_f32_16x16x32_bf16 v[36:39], v[152:155], v[136:139], v[36:39]
    ds_read_b64_tr_b16 v[116:117], v181 offset:32
    v_mfma_f32_16x16x32_bf16 v[40:43], v[152:155], v[140:143], v[40:43]
    ds_read_b64_tr_b16 v[118:119], v181 offset:1312
    v_mfma_f32_16x16x32_bf16 v[44:47], v[152:155], v[144:147], v[44:47]
    ds_read_b128 v[104:107], v176 offset:4096
    s_add_u32 s86, s86, 128
    s_cmp_eq_u32 s86, s87
    s_cselect_b32 s86, s55, s86
    s_add_u32 m0, s57, 73728
    s_nop 0
    buffer_load_dwordx4 v2, s[28:31], s86 offen offset:0 lds
    v_mfma_f32_16x16x32_bf16 v[48:51], v[156:159], v[132:135], v[48:51]
    ds_read_b64_tr_b16 v[120:121], v180 offset:64
    v_mfma_f32_16x16x32_bf16 v[52:55], v[156:159], v[136:139], v[52:55]
    ds_read_b64_tr_b16 v[122:123], v180 offset:1344
    v_mfma_f32_16x16x32_bf16 v[56:59], v[156:159], v[140:143], v[56:59]
    ds_read_b128 v[108:111], v176 offset:6144
    v_mfma_f32_16x16x32_bf16 v[60:63], v[156:159], v[144:147], v[60:63]
    ds_read_b64_tr_b16 v[124:125], v181 offset:96
    s_add_u32 m0, s57, 73728
    s_nop 0
    buffer_load_dwordx4 v3, s[28:31], s86 offen offset:1024 lds
    v_mfma_f32_16x16x32_bf16 v[64:67], v[160:163], v[132:135], v[64:67]
    ds_read_b64_tr_b16 v[126:127], v181 offset:1376
    v_mfma_f32_16x16x32_bf16 v[68:71], v[160:163], v[136:139], v[68:71]
    ds_read_b64_tr_b16 v[128:129], v180 offset:128
    v_mfma_f32_16x16x32_bf16 v[72:75], v[160:163], v[140:143], v[72:75]
    ds_read_b64_tr_b16 v[130:131], v180 offset:1408
    v_mfma_f32_16x16x32_bf16 v[76:79], v[160:163], v[144:147], v[76:79]
    s_add_u32 m0, s57, 73728
    s_nop 0
    buffer_load_dwordx4 v4, s[28:31], s86 offen offset:2048 lds
    v_mfma_f32_16x16x32_bf16 v[80:83], v[164:167], v[132:135], v[80:83]
    v_mfma_f32_16x16x32_bf16 v[84:87], v[164:167], v[136:139], v[84:87]
    v_mfma_f32_16x16x32_bf16 v[88:91], v[164:167], v[140:143], v[88:91]
    v_mfma_f32_16x16x32_bf16 v[92:95], v[164:167], v[144:147], v[92:95]
    s_add_u32 m0, s57, 73728
    s_nop 0
    buffer_load_dwordx4 v5, s[28:31], s86 offen offset:3072 lds
    s_waitcnt lgkmcnt(0)
    v_mfma_f32_16x16x32_bf16 v[16:19], v[112:115], v[96:99], v[16:19]
    v_mfma_f32_16x16x32_bf16 v[20:23], v[112:115], v[100:103], v[20:23]
    ds_read_b128 v[132:135], v177 offset:0
    v_mfma_f32_16x16x32_bf16 v[24:27], v[112:115], v[104:107], v[24:27]
    ds_read_b64_tr_b16 v[148:149], v180 offset:10240
    v_mfma_f32_16x16x32_bf16 v[28:31], v[112:115], v[108:111], v[28:31]
    ds_read_b64_tr_b16 v[150:151], v180 offset:11520
    s_add_u32 s88, s88, 81920
    s_cmp_eq_u32 s88, s90
    s_cselect_b32 s88, s56, s88
    s_add_u32 m0, s58, 73728
    s_nop 0
    buffer_load_dwordx4 v6, s[32:35], s88 offen offset:0 lds
    v_mfma_f32_16x16x32_bf16 v[32:35], v[116:119], v[96:99], v[32:35]
    ds_read_b128 v[136:139], v177 offset:2048
    v_mfma_f32_16x16x32_bf16 v[36:39], v[116:119], v[100:103], v[36:39]
    ds_read_b64_tr_b16 v[152:153], v181 offset:10272
    v_mfma_f32_16x16x32_bf16 v[40:43], v[116:119], v[104:107], v[40:43]
    ds_read_b64_tr_b16 v[154:155], v181 offset:11552
    v_mfma_f32_16x16x32_bf16 v[44:47], v[116:119], v[108:111], v[44:47]
    ds_read_b128 v[140:143], v177 offset:4096
    s_add_u32 m0, s58, 73728
    s_nop 0
    buffer_load_dwordx4 v7, s[32:35], s88 offen offset:1024 lds
    v_mfma_f32_16x16x32_bf16 v[48:51], v[120:123], v[96:99], v[48:51]
    ds_read_b64_tr_b16 v[156:157], v180 offset:10304
    v_mfma_f32_16x16x32_bf16 v[52:55], v[120:123], v[100:103], v[52:55]
    ds_read_b64_tr_b16 v[158:159], v180 offset:11584
    v_mfma_f32_16x16x32_bf16 v[56:59], v[120:123], v[104:107], v[56:59]
    ds_read_b128 v[144:147], v177 offset:6144
    v_mfma_f32_16x16x32_bf16 v[60:63], v[120:123], v[108:111], v[60:63]
    ds_read_b64_tr_b16 v[160:161], v181 offset:10336
    s_add_u32 m0, s58, 73728
    s_nop 0
    buffer_load_dwordx4 v8, s[32:35], s88 offen offset:2048 lds
    v_mfma_f32_16x16x32_bf16 v[64:67], v[124:127], v[96:99], v[64:67]
    ds_read_b64_tr_b16 v[162:163], v181 offset:11616
    v_mfma_f32_16x16x32_bf16 v[68:71], v[124:127], v[100:103], v[68:71]
    ds_read_b64_tr_b16 v[164:165], v180 offset:10368
    v_mfma_f32_16x16x32_bf16 v[72:75], v[124:127], v[104:107], v[72:75]
    ds_read_b64_tr_b16 v[166:167], v180 offset:11648
    v_mfma_f32_16x16x32_bf16 v[76:79], v[124:127], v[108:111], v[76:79]
    s_add_u32 m0, s58, 73728
    s_nop 0
    buffer_load_dwordx4 v9, s[32:35], s88 offen offset:3072 lds
    v_mfma_f32_16x16x32_bf16 v[80:83], v[128:131], v[96:99], v[80:83]
    v_mfma_f32_16x16x32_bf16 v[84:87], v[128:131], v[100:103], v[84:87]
    v_mfma_f32_16x16x32_bf16 v[88:91], v[128:131], v[104:107], v[88:91]
    v_mfma_f32_16x16x32_bf16 v[92:95], v[128:131], v[108:111], v[92:95]
    s_add_u32 m0, s58, 77824
    s_nop 0
    buffer_load_dwordx4 v11, s[32:35], s88 offen offset:0 lds
    s_waitcnt lgkmcnt(0)
    v_mfma_f32_16x16x32_bf16 v[16:19], v[148:151], v[132:135], v[16:19]
    v_mfma_f32_16x16x32_bf16 v[20:23], v[148:151], v[136:139], v[20:23]
    s_waitcnt vmcnt(9)
    s_barrier
    ds_read_b128 v[96:99], v176 offset:36864
    v_mfma_f32_16x16x32_bf16 v[24:27], v[148:151], v[140:143], v[24:27]
    ds_read_b64_tr_b16 v[112:113], v180 offset:36864
    v_mfma_f32_16x16x32_bf16 v[28:31], v[148:151], v[144:147], v[28:31]
    ds_read_b64_tr_b16 v[114:115], v180 offset:38144
    s_add_u32 s86, s86, 128
    s_cmp_eq_u32 s86, s87
    s_cselect_b32 s86, s55, s86
    s_add_u32 m0, s57, 110592
    s_nop 0
    buffer_load_dwordx4 v2, s[28:31], s86 offen offset:0 lds
    v_mfma_f32_16x16x32_bf16 v[32:35], v[152:155], v[132:135], v[32:35]
    ds_read_b128 v[100:103], v176 offset:38912
    v_mfma_f32_16x16x32_bf16 v[36:39], v[152:155], v[136:139], v[36:39]
    ds_read_b64_tr_b16 v[116:117], v181 offset:36896
    v_mfma_f32_16x16x32_bf16 v[40:43], v[152:155], v[140:143], v[40:43]
    ds_read_b64_tr_b16 v[118:119], v181 offset:38176
    v_mfma_f32_16x16x32_bf16 v[44:47], v[152:155], v[144:147], v[44:47]
    ds_read_b128 v[104:107], v176 offset:40960
    s_add_u32 m0, s57, 110592
    s_nop 0
    buffer_load_dwordx4 v3, s[28:31], s86 offen offset:1024 lds
    v_mfma_f32_16x16x32_bf16 v[48:51], v[156:159], v[132:135], v[48:51]
    ds_read_b64_tr_b16 v[120:121], v180 offset:36928
    v_mfma_f32_16x16x32_bf16 v[52:55], v[156:159], v[136:139], v[52:55]
    ds_read_b64_tr_b16 v[122:123], v180 offset:38208
    v_mfma_f32_16x16x32_bf16 v[56:59], v[156:159], v[140:143], v[56:59]
    ds_read_b128 v[108:111], v176 offset:43008
    v_mfma_f32_16x16x32_bf16 v[60:63], v[156:159], v[144:147], v[60:63]
    ds_read_b64_tr_b16 v[124:125], v181 offset:36960
    s_add_u32 m0, s57, 110592
    s_nop 0
    buffer_load_dwordx4 v4, s[28:31], s86 offen offset:2048 lds
    v_mfma_f32_16x16x32_bf16 v[64:67], v[160:163], v[132:135], v[64:67]
    ds_read_b64_tr_b16 v[126:127], v181 offset:38240
    v_mfma_f32_16x16x32_bf16 v[68:71], v[160:163], v[136:139], v[68:71]
    ds_read_b64_tr_b16 v[128:129], v180 offset:36992
    v_mfma_f32_16x16x32_bf16 v[72:75], v[160:163], v[140:143], v[72:75]
    ds_read_b64_tr_b16 v[130:131], v180 offset:38272
    v_mfma_f32_16x16x32_bf16 v[76:79], v[160:163], v[144:147], v[76:79]
    s_add_u32 m0, s57, 110592
    s_nop 0
    buffer_load_dwordx4 v5, s[28:31], s86 offen offset:3072 lds
    v_mfma_f32_16x16x32_bf16 v[80:83], v[164:167], v[132:135], v[80:83]
    v_mfma_f32_16x16x32_bf16 v[84:87], v[164:167], v[136:139], v[84:87]
    v_mfma_f32_16x16x32_bf16 v[88:91], v[164:167], v[140:143], v[88:91]
    v_mfma_f32_16x16x32_bf16 v[92:95], v[164:167], v[144:147], v[92:95]
    s_add_u32 s88, s88, 81920
    s_cmp_eq_u32 s88, s90
    s_cselect_b32 s88, s56, s88
    s_add_u32 m0, s58, 110592
    s_nop 0
    buffer_load_dwordx4 v6, s[32:35], s88 offen offset:0 lds
    s_waitcnt lgkmcnt(0)
    v_mfma_f32_16x16x32_bf16 v[16:19], v[112:115], v[96:99], v[16:19]
    v_mfma_f32_16x16x32_bf16 v[20:23], v[112:115], v[100:103], v[20:23]
    ds_read_b128 v[132:135], v177 offset:36864
    v_mfma_f32_16x16x32_bf16 v[24:27], v[112:115], v[104:107], v[24:27]
    ds_read_b64_tr_b16 v[148:149], v180 offset:47104
    v_mfma_f32_16x16x32_bf16 v[28:31], v[112:115], v[108:111], v[28:31]
    ds_read_b64_tr_b16 v[150:151], v180 offset:48384
    s_add_u32 m0, s58, 110592
    s_nop 0
    buffer_load_dwordx4 v7, s[32:35], s88 offen offset:1024 lds
    v_mfma_f32_16x16x32_bf16 v[32:35], v[116:119], v[96:99], v[32:35]
    ds_read_b128 v[136:139], v177 offset:38912
    v_mfma_f32_16x16x32_bf16 v[36:39], v[116:119], v[100:103], v[36:39]
    ds_read_b64_tr_b16 v[152:153], v181 offset:47136
    v_mfma_f32_16x16x32_bf16 v[40:43], v[116:119], v[104:107], v[40:43]
    ds_read_b64_tr_b16 v[154:155], v181 offset:48416
    v_mfma_f32_16x16x32_bf16 v[44:47], v[116:119], v[108:111], v[44:47]
    ds_read_b128 v[140:143], v177 offset:40960
    s_add_u32 m0, s58, 110592
    s_nop 0
    buffer_load_dwordx4 v8, s[32:35], s88 offen offset:2048 lds
    v_mfma_f32_16x16x32_bf16 v[48:51], v[120:123], v[96:99], v[48:51]
    ds_read_b64_tr_b16 v[156:157], v180 offset:47168
    v_mfma_f32_16x16x32_bf16 v[52:55], v[120:123], v[100:103], v[52:55]
    ds_read_b64_tr_b16 v[158:159], v180 offset:48448
    v_mfma_f32_16x16x32_bf16 v[56:59], v[120:123], v[104:107], v[56:59]
    ds_read_b128 v[144:147], v177 offset:43008
    v_mfma_f32_16x16x32_bf16 v[60:63], v[120:123], v[108:111], v[60:63]
    ds_read_b64_tr_b16 v[160:161], v181 offset:47200
    s_add_u32 m0, s58, 110592
    s_nop 0
    buffer_load_dwordx4 v9, s[32:35], s88 offen offset:3072 lds
    v_mfma_f32_16x16x32_bf16 v[64:67], v[124:127], v[96:99], v[64:67]
    ds_read_b64_tr_b16 v[162:163], v181 offset:48480
    v_mfma_f32_16x16x32_bf16 v[68:71], v[124:127], v[100:103], v[68:71]
    ds_read_b64_tr_b16 v[164:165], v180 offset:47232
    v_mfma_f32_16x16x32_bf16 v[72:75], v[124:127], v[104:107], v[72:75]
    ds_read_b64_tr_b16 v[166:167], v180 offset:48512
    v_mfma_f32_16x16x32_bf16 v[76:79], v[124:127], v[108:111], v[76:79]
    s_add_u32 m0, s58, 114688
    s_nop 0
    buffer_load_dwordx4 v11, s[32:35], s88 offen offset:0 lds
    v_mfma_f32_16x16x32_bf16 v[80:83], v[128:131], v[96:99], v[80:83]
    v_mfma_f32_16x16x32_bf16 v[84:87], v[128:131], v[100:103], v[84:87]
    v_mfma_f32_16x16x32_bf16 v[88:91], v[128:131], v[104:107], v[88:91]
    v_mfma_f32_16x16x32_bf16 v[92:95], v[128:131], v[108:111], v[92:95]
    s_add_u32 s86, s86, 128
    s_cmp_eq_u32 s86, s87
    s_cselect_b32 s86, s55, s86
    s_add_u32 m0, s57, 0
    s_nop 0
    buffer_load_dwordx4 v2, s[28:31], s86 offen offset:0 lds
    s_waitcnt lgkmcnt(0)
    v_mfma_f32_16x16x32_bf16 v[16:19], v[148:151], v[132:135], v[16:19]
    v_mfma_f32_16x16x32_bf16 v[20:23], v[148:151], v[136:139], v[20:23]
    s_waitcnt vmcnt(10)
    s_barrier
    ds_read_b128 v[96:99], v178 offset:0
    v_mfma_f32_16x16x32_bf16 v[24:27], v[148:151], v[140:143], v[24:27]
    ds_read_b64_tr_b16 v[112:113], v182 offset:0
    v_mfma_f32_16x16x32_bf16 v[28:31], v[148:151], v[144:147], v[28:31]
    ds_read_b64_tr_b16 v[114:115], v182 offset:1280
    s_add_u32 m0, s57, 0
    s_nop 0
    buffer_load_dwordx4 v3, s[28:31], s86 offen offset:1024 lds
    v_mfma_f32_16x16x32_bf16 v[32:35], v[152:155], v[132:135], v[32:35]
    ds_read_b128 v[100:103], v178 offset:2048
    v_mfma_f32_16x16x32_bf16 v[36:39], v[152:155], v[136:139], v[36:39]
    ds_read_b64_tr_b16 v[116:117], v183 offset:32
    v_mfma_f32_16x16x32_bf16 v[40:43], v[152:155], v[140:143], v[40:43]
    ds_read_b64_tr_b16 v[118:119], v183 offset:1312
    v_mfma_f32_16x16x32_bf16 v[44:47], v[152:155], v[144:147], v[44:47]
    ds_read_b128 v[104:107], v178 offset:4096
    s_add_u32 m0, s57, 0
    s_nop 0
    buffer_load_dwordx4 v4, s[28:31], s86 offen offset:2048 lds
    v_mfma_f32_16x16x32_bf16 v[48:51], v[156:159], v[132:135], v[48:51]
    ds_read_b64_tr_b16 v[120:121], v182 offset:64
    v_mfma_f32_16x16x32_bf16 v[52:55], v[156:159], v[136:139], v[52:55]
    ds_read_b64_tr_b16 v[122:123], v182 offset:1344
    v_mfma_f32_16x16x32_bf16 v[56:59], v[156:159], v[140:143], v[56:59]
    ds_read_b128 v[108:111], v178 offset:6144
    v_mfma_f32_16x16x32_bf16 v[60:63], v[156:159], v[144:147], v[60:63]
    ds_read_b64_tr_b16 v[124:125], v183 offset:96
    s_add_u32 m0, s57, 0
    s_nop 0
    buffer_load_dwordx4 v5, s[28:31], s86 offen offset:3072 lds
    v_mfma_f32_16x16x32_bf16 v[64:67], v[160:163], v[132:135], v[64:67]
    ds_read_b64_tr_b16 v[126:127], v183 offset:1376
    v_mfma_f32_16x16x32_bf16 v[68:71], v[160:163], v[136:139], v[68:71]
    ds_read_b64_tr_b16 v[128:129], v182 offset:128
    v_mfma_f32_16x16x32_bf16 v[72:75], v[160:163], v[140:143], v[72:75]
    ds_read_b64_tr_b16 v[130:131], v182 offset:1408
    v_mfma_f32_16x16x32_bf16 v[76:79], v[160:163], v[144:147], v[76:79]
    s_add_u32 s88, s88, 81920
    s_cmp_eq_u32 s88, s90
    s_cselect_b32 s88, s56, s88
    s_add_u32 m0, s58, 0
    s_nop 0
    buffer_load_dwordx4 v6, s[32:35], s88 offen offset:0 lds
    v_mfma_f32_16x16x32_bf16 v[80:83], v[164:167], v[132:135], v[80:83]
    v_mfma_f32_16x16x32_bf16 v[84:87], v[164:167], v[136:139], v[84:87]
    v_mfma_f32_16x16x32_bf16 v[88:91], v[164:167], v[140:143], v[88:91]
    v_mfma_f32_16x16x32_bf16 v[92:95], v[164:167], v[144:147], v[92:95]
    s_add_u32 m0, s58, 0
    s_nop 0
    buffer_load_dwordx4 v7, s[32:35], s88 offen offset:1024 lds
    s_waitcnt lgkmcnt(0)
    v_mfma_f32_16x16x32_bf16 v[16:19], v[112:115], v[96:99], v[16:19]
    v_mfma_f32_16x16x32_bf16 v[20:23], v[112:115], v[100:103], v[20:23]
    ds_read_b128 v[132:135], v179 offset:0
    v_mfma_f32_16x16x32_bf16 v[24:27], v[112:115], v[104:107], v[24:27]
    ds_read_b64_tr_b16 v[148:149], v182 offset:10240
    v_mfma_f32_16x16x32_bf16 v[28:31], v[112:115], v[108:111], v[28:31]
    ds_read_b64_tr_b16 v[150:151], v182 offset:11520
    s_add_u32 m0, s58, 0
    s_nop 0
    buffer_load_dwordx4 v8, s[32:35], s88 offen offset:2048 lds
    v_mfma_f32_16x16x32_bf16 v[32:35], v[116:119], v[96:99], v[32:35]
    ds_read_b128 v[136:139], v179 offset:2048
    v_mfma_f32_16x16x32_bf16 v[36:39], v[116:119], v[100:103], v[36:39]
    ds_read_b64_tr_b16 v[152:153], v183 offset:10272
    v_mfma_f32_16x16x32_bf16 v[40:43], v[116:119], v[104:107], v[40:43]
    ds_read_b64_tr_b16 v[154:155], v183 offset:11552
    v_mfma_f32_16x16x32_bf16 v[44:47], v[116:119], v[108:111], v[44:47]
    ds_read_b128 v[140:143], v179 offset:4096
    s_add_u32 m0, s58, 0
    s_nop 0
    buffer_load_dwordx4 v9, s[32:35], s88 offen offset:3072 lds
    v_mfma_f32_16x16x32_bf16 v[48:51], v[120:123], v[96:99], v[48:51]
    ds_read_b64_tr_b16 v[156:157], v182 offset:10304
    v_mfma_f32_16x16x32_bf16 v[52:55], v[120:123], v[100:103], v[52:55]
    ds_read_b64_tr_b16 v[158:159], v182 offset:11584
    v_mfma_f32_16x16x32_bf16 v[56:59], v[120:123], v[104:107], v[56:59]
    ds_read_b128 v[144:147], v179 offset:6144
    v_mfma_f32_16x16x32_bf16 v[60:63], v[120:123], v[108:111], v[60:63]
    ds_read_b64_tr_b16 v[160:161], v183 offset:10336
    s_add_u32 m0, s58, 4096
    s_nop 0
    buffer_load_dwordx4 v11, s[32:35], s88 offen offset:0 lds
    v_mfma_f32_16x16x32_bf16 v[64:67], v[124:127], v[96:99], v[64:67]
    ds_read_b64_tr_b16 v[162:163], v183 offset:11616
    v_mfma_f32_16x16x32_bf16 v[68:71], v[124:127], v[100:103], v[68:71]
    ds_read_b64_tr_b16 v[164:165], v182 offset:10368
    v_mfma_f32_16x16x32_bf16 v[72:75], v[124:127], v[104:107], v[72:75]
    ds_read_b64_tr_b16 v[166:167], v182 offset:11648
    v_mfma_f32_16x16x32_bf16 v[76:79], v[124:127], v[108:111], v[76:79]
    s_add_u32 s86, s86, 128
    s_cmp_eq_u32 s86, s87
    s_cselect_b32 s86, s55, s86
    s_add_u32 m0, s57, 36864
    s_nop 0
    buffer_load_dwordx4 v2, s[28:31], s86 offen offset:0 lds
    v_mfma_f32_16x16x32_bf16 v[80:83], v[128:131], v[96:99], v[80:83]
    v_mfma_f32_16x16x32_bf16 v[84:87], v[128:131], v[100:103], v[84:87]
    v_mfma_f32_16x16x32_bf16 v[88:91], v[128:131], v[104:107], v[88:91]
    v_mfma_f32_16x16x32_bf16 v[92:95], v[128:131], v[108:111], v[92:95]
    s_add_u32 m0, s57, 36864
    s_nop 0
    buffer_load_dwordx4 v3, s[28:31], s86 offen offset:1024 lds
    s_waitcnt lgkmcnt(0)
    v_mfma_f32_16x16x32_bf16 v[16:19], v[148:151], v[132:135], v[16:19]
    v_mfma_f32_16x16x32_bf16 v[20:23], v[148:151], v[136:139], v[20:23]
    s_waitcnt vmcnt(11)
    s_barrier
    ds_read_b128 v[96:99], v178 offset:36864
    v_mfma_f32_16x16x32_bf16 v[24:27], v[148:151], v[140:143], v[24:27]
    ds_read_b64_tr_b16 v[112:113], v182 offset:36864
    v_mfma_f32_16x16x32_bf16 v[28:31], v[148:151], v[144:147], v[28:31]
    ds_read_b64_tr_b16 v[114:115], v182 offset:38144
    s_add_u32 m0, s57, 36864
    s_nop 0
    buffer_load_dwordx4 v4, s[28:31], s86 offen offset:2048 lds
    v_mfma_f32_16x16x32_bf16 v[32:35], v[152:155], v[132:135], v[32:35]
    ds_read_b128 v[100:103], v178 offset:38912
    v_mfma_f32_16x16x32_bf16 v[36:39], v[152:155], v[136:139], v[36:39]
    ds_read_b64_tr_b16 v[116:117], v183 offset:36896
    v_mfma_f32_16x16x32_bf16 v[40:43], v[152:155], v[140:143], v[40:43]
    ds_read_b64_tr_b16 v[118:119], v183 offset:38176
    v_mfma_f32_16x16x32_bf16 v[44:47], v[152:155], v[144:147], v[44:47]
    ds_read_b128 v[104:107], v178 offset:40960
    s_add_u32 m0, s57, 36864
    s_nop 0
    buffer_load_dwordx4 v5, s[28:31], s86 offen offset:3072 lds
    v_mfma_f32_16x16x32_bf16 v[48:51], v[156:159], v[132:135], v[48:51]
    ds_read_b64_tr_b16 v[120:121], v182 offset:36928
    v_mfma_f32_16x16x32_bf16 v[52:55], v[156:159], v[136:139], v[52:55]
    ds_read_b64_tr_b16 v[122:123], v182 offset:38208
    v_mfma_f32_16x16x32_bf16 v[56:59], v[156:159], v[140:143], v[56:59]
    ds_read_b128 v[108:111], v178 offset:43008
    v_mfma_f32_16x16x32_bf16 v[60:63], v[156:159], v[144:147], v[60:63]
    ds_read_b64_tr_b16 v[124:125], v183 offset:36960
    s_add_u32 s88, s88, 81920
    s_cmp_eq_u32 s88, s90
    s_cselect_b32 s88, s56, s88
    s_add_u32 m0, s58, 36864
    s_nop 0
    buffer_load_dwordx4 v6, s[32:35], s88 offen offset:0 lds
    v_mfma_f32_16x16x32_bf16 v[64:67], v[160:163], v[132:135], v[64:67]
    ds_read_b64_tr_b16 v[126:127], v183 offset:38240
    v_mfma_f32_16x16x32_bf16 v[68:71], v[160:163], v[136:139], v[68:71]
    ds_read_b64_tr_b16 v[128:129], v182 offset:36992
    v_mfma_f32_16x16x32_bf16 v[72:75], v[160:163], v[140:143], v[72:75]
    ds_read_b64_tr_b16 v[130:131], v182 offset:38272
    v_mfma_f32_16x16x32_bf16 v[76:79], v[160:163], v[144:147], v[76:79]
    s_add_u32 m0, s58, 36864
    s_nop 0
    buffer_load_dwordx4 v7, s[32:35], s88 offen offset:1024 lds
    v_mfma_f32_16x16x32_bf16 v[80:83], v[164:167], v[132:135], v[80:83]
    v_mfma_f32_16x16x32_bf16 v[84:87], v[164:167], v[136:139], v[84:87]
    v_mfma_f32_16x16x32_bf16 v[88:91], v[164:167], v[140:143], v[88:91]
    v_mfma_f32_16x16x32_bf16 v[92:95], v[164:167], v[144:147], v[92:95]
    s_add_u32 m0, s58, 36864
    s_nop 0
    buffer_load_dwordx4 v8, s[32:35], s88 offen offset:2048 lds
    s_waitcnt lgkmcnt(0)
    v_mfma_f32_16x16x32_bf16 v[16:19], v[112:115], v[96:99], v[16:19]
    v_mfma_f32_16x16x32_bf16 v[20:23], v[112:115], v[100:103], v[20:23]
    ds_read_b128 v[132:135], v179 offset:36864
    v_mfma_f32_16x16x32_bf16 v[24:27], v[112:115], v[104:107], v[24:27]
    ds_read_b64_tr_b16 v[148:149], v182 offset:47104
    v_mfma_f32_16x16x32_bf16 v[28:31], v[112:115], v[108:111], v[28:31]
    ds_read_b64_tr_b16 v[150:151], v182 offset:48384
    s_add_u32 m0, s58, 36864
    s_nop 0
    buffer_load_dwordx4 v9, s[32:35], s88 offen offset:3072 lds
    v_mfma_f32_16x16x32_bf16 v[32:35], v[116:119], v[96:99], v[32:35]
    ds_read_b128 v[136:139], v179 offset:38912
    v_mfma_f32_16x16x32_bf16 v[36:39], v[116:119], v[100:103], v[36:39]
    ds_read_b64_tr_b16 v[152:153], v183 offset:47136
    v_mfma_f32_16x16x32_bf16 v[40:43], v[116:119], v[104:107], v[40:43]
    ds_read_b64_tr_b16 v[154:155], v183 offset:48416
    v_mfma_f32_16x16x32_bf16 v[44:47], v[116:119], v[108:111], v[44:47]
    ds_read_b128 v[140:143], v179 offset:40960
    s_add_u32 m0, s58, 40960
    s_nop 0
    buffer_load_dwordx4 v11, s[32:35], s88 offen offset:0 lds
    v_mfma_f32_16x16x32_bf16 v[48:51], v[120:123], v[96:99], v[48:51]
    ds_read_b64_tr_b16 v[156:157], v182 offset:47168
    v_mfma_f32_16x16x32_bf16 v[52:55], v[120:123], v[100:103], v[52:55]
    ds_read_b64_tr_b16 v[158:159], v182 offset:48448
    v_mfma_f32_16x16x32_bf16 v[56:59], v[120:123], v[104:107], v[56:59]
    ds_read_b128 v[144:147], v179 offset:43008
    v_mfma_f32_16x16x32_bf16 v[60:63], v[120:123], v[108:111], v[60:63]
    ds_read_b64_tr_b16 v[160:161], v183 offset:47200
    v_mfma_f32_16x16x32_bf16 v[64:67], v[124:127], v[96:99], v[64:67]
    ds_read_b64_tr_b16 v[162:163], v183 offset:48480
    v_mfma_f32_16x16x32_bf16 v[68:71], v[124:127], v[100:103], v[68:71]
    ds_read_b64_tr_b16 v[164:165], v182 offset:47232
    v_mfma_f32_16x16x32_bf16 v[72:75], v[124:127], v[104:107], v[72:75]
    ds_read_b64_tr_b16 v[166:167], v182 offset:48512
    v_mfma_f32_16x16x32_bf16 v[76:79], v[124:127], v[108:111], v[76:79]
    v_mfma_f32_16x16x32_bf16 v[80:83], v[128:131], v[96:99], v[80:83]
    v_mfma_f32_16x16x32_bf16 v[84:87], v[128:131], v[100:103], v[84:87]
    v_mfma_f32_16x16x32_bf16 v[88:91], v[128:131], v[104:107], v[88:91]
    v_mfma_f32_16x16x32_bf16 v[92:95], v[128:131], v[108:111], v[92:95]
    s_waitcnt lgkmcnt(0)
    v_mfma_f32_16x16x32_bf16 v[16:19], v[148:151], v[132:135], v[16:19]
    v_mfma_f32_16x16x32_bf16 v[20:23], v[148:151], v[136:139], v[20:23]
    s_waitcnt vmcnt(9)
    s_barrier
    ds_read_b128 v[96:99], v176 offset:0
    v_mfma_f32_16x16x32_bf16 v[24:27], v[148:151], v[140:143], v[24:27]
    ds_read_b64_tr_b16 v[112:113], v180 offset:0
    v_mfma_f32_16x16x32_bf16 v[28:31], v[148:151], v[144:147], v[28:31]
    ds_read_b64_tr_b16 v[114:115], v180 offset:1280
    v_mfma_f32_16x16x32_bf16 v[32:35], v[152:155], v[132:135], v[32:35]
    ds_read_b128 v[100:103], v176 offset:2048
    v_mfma_f32_16x16x32_bf16 v[36:39], v[152:155], v[136:139], v[36:39]
    ds_read_b64_tr_b16 v[116:117], v181 offset:32
    v_mfma_f32_16x16x32_bf16 v[40:43], v[152:155], v[140:143], v[40:43]
    ds_read_b64_tr_b16 v[118:119], v181 offset:1312
    v_mfma_f32_16x16x32_bf16 v[44:47], v[152:155], v[144:147], v[44:47]
    ds_read_b128 v[104:107], v176 offset:4096
    v_mfma_f32_16x16x32_bf16 v[48:51], v[156:159], v[132:135], v[48:51]
    ds_read_b64_tr_b16 v[120:121], v180 offset:64
    v_mfma_f32_16x16x32_bf16 v[52:55], v[156:159], v[136:139], v[52:55]
    ds_read_b64_tr_b16 v[122:123], v180 offset:1344
    v_mfma_f32_16x16x32_bf16 v[56:59], v[156:159], v[140:143], v[56:59]
    ds_read_b128 v[108:111], v176 offset:6144
    v_mfma_f32_16x16x32_bf16 v[60:63], v[156:159], v[144:147], v[60:63]
    ds_read_b64_tr_b16 v[124:125], v181 offset:96
    v_mfma_f32_16x16x32_bf16 v[64:67], v[160:163], v[132:135], v[64:67]
    ds_read_b64_tr_b16 v[126:127], v181 offset:1376
    v_mfma_f32_16x16x32_bf16 v[68:71], v[160:163], v[136:139], v[68:71]
    ds_read_b64_tr_b16 v[128:129], v180 offset:128
    v_mfma_f32_16x16x32_bf16 v[72:75], v[160:163], v[140:143], v[72:75]
    ds_read_b64_tr_b16 v[130:131], v180 offset:1408
    v_mfma_f32_16x16x32_bf16 v[76:79], v[160:163], v[144:147], v[76:79]
    v_mfma_f32_16x16x32_bf16 v[80:83], v[164:167], v[132:135], v[80:83]
    v_mfma_f32_16x16x32_bf16 v[84:87], v[164:167], v[136:139], v[84:87]
    v_mfma_f32_16x16x32_bf16 v[88:91], v[164:167], v[140:143], v[88:91]
    v_mfma_f32_16x16x32_bf16 v[92:95], v[164:167], v[144:147], v[92:95]
    s_waitcnt lgkmcnt(0)
    v_mfma_f32_16x16x32_bf16 v[16:19], v[112:115], v[96:99], v[16:19]
    v_mfma_f32_16x16x32_bf16 v[20:23], v[112:115], v[100:103], v[20:23]
    ds_read_b128 v[132:135], v177 offset:0
    v_mfma_f32_16x16x32_bf16 v[24:27], v[112:115], v[104:107], v[24:27]
    ds_read_b64_tr_b16 v[148:149], v180 offset:10240
    v_mfma_f32_16x16x32_bf16 v[28:31], v[112:115], v[108:111], v[28:31]
    ds_read_b64_tr_b16 v[150:151], v180 offset:11520
    v_mfma_f32_16x16x32_bf16 v[32:35], v[116:119], v[96:99], v[32:35]
    ds_read_b128 v[136:139], v177 offset:2048
    v_mfma_f32_16x16x32_bf16 v[36:39], v[116:119], v[100:103], v[36:39]
    ds_read_b64_tr_b16 v[152:153], v181 offset:10272
    v_mfma_f32_16x16x32_bf16 v[40:43], v[116:119], v[104:107], v[40:43]
    ds_read_b64_tr_b16 v[154:155], v181 offset:11552
    v_mfma_f32_16x16x32_bf16 v[44:47], v[116:119], v[108:111], v[44:47]
    ds_read_b128 v[140:143], v177 offset:4096
    v_mfma_f32_16x16x32_bf16 v[48:51], v[120:123], v[96:99], v[48:51]
    ds_read_b64_tr_b16 v[156:157], v180 offset:10304
    v_mfma_f32_16x16x32_bf16 v[52:55], v[120:123], v[100:103], v[52:55]
    ds_read_b64_tr_b16 v[158:159], v180 offset:11584
    v_mfma_f32_16x16x32_bf16 v[56:59], v[120:123], v[104:107], v[56:59]
    ds_read_b128 v[144:147], v177 offset:6144
    v_mfma_f32_16x16x32_bf16 v[60:63], v[120:123], v[108:111], v[60:63]
    ds_read_b64_tr_b16 v[160:161], v181 offset:10336
    v_mfma_f32_16x16x32_bf16 v[64:67], v[124:127], v[96:99], v[64:67]
    ds_read_b64_tr_b16 v[162:163], v181 offset:11616
    v_mfma_f32_16x16x32_bf16 v[68:71], v[124:127], v[100:103], v[68:71]
    ds_read_b64_tr_b16 v[164:165], v180 offset:10368
    v_mfma_f32_16x16x32_bf16 v[72:75], v[124:127], v[104:107], v[72:75]
    ds_read_b64_tr_b16 v[166:167], v180 offset:11648
    v_mfma_f32_16x16x32_bf16 v[76:79], v[124:127], v[108:111], v[76:79]
    v_mfma_f32_16x16x32_bf16 v[80:83], v[128:131], v[96:99], v[80:83]
    v_mfma_f32_16x16x32_bf16 v[84:87], v[128:131], v[100:103], v[84:87]
    v_mfma_f32_16x16x32_bf16 v[88:91], v[128:131], v[104:107], v[88:91]
    v_mfma_f32_16x16x32_bf16 v[92:95], v[128:131], v[108:111], v[92:95]
    s_waitcnt lgkmcnt(0)
    v_mfma_f32_16x16x32_bf16 v[16:19], v[148:151], v[132:135], v[16:19]
    v_mfma_f32_16x16x32_bf16 v[20:23], v[148:151], v[136:139], v[20:23]
    s_waitcnt vmcnt(0)
    s_barrier
    ds_read_b128 v[96:99], v176 offset:36864
    v_mfma_f32_16x16x32_bf16 v[24:27], v[148:151], v[140:143], v[24:27]
    ds_read_b64_tr_b16 v[112:113], v180 offset:36864
    v_mfma_f32_16x16x32_bf16 v[28:31], v[148:151], v[144:147], v[28:31]
    ds_read_b64_tr_b16 v[114:115], v180 offset:38144
    v_mfma_f32_16x16x32_bf16 v[32:35], v[152:155], v[132:135], v[32:35]
    ds_read_b128 v[100:103], v176 offset:38912
    v_mfma_f32_16x16x32_bf16 v[36:39], v[152:155], v[136:139], v[36:39]
    ds_read_b64_tr_b16 v[116:117], v181 offset:36896
    v_mfma_f32_16x16x32_bf16 v[40:43], v[152:155], v[140:143], v[40:43]
    ds_read_b64_tr_b16 v[118:119], v181 offset:38176
    v_mfma_f32_16x16x32_bf16 v[44:47], v[152:155], v[144:147], v[44:47]
    ds_read_b128 v[104:107], v176 offset:40960
    v_mfma_f32_16x16x32_bf16 v[48:51], v[156:159], v[132:135], v[48:51]
    ds_read_b64_tr_b16 v[120:121], v180 offset:36928
    v_mfma_f32_16x16x32_bf16 v[52:55], v[156:159], v[136:139], v[52:55]
    ds_read_b64_tr_b16 v[122:123], v180 offset:38208
    v_mfma_f32_16x16x32_bf16 v[56:59], v[156:159], v[140:143], v[56:59]
    ds_read_b128 v[108:111], v176 offset:43008
    v_mfma_f32_16x16x32_bf16 v[60:63], v[156:159], v[144:147], v[60:63]
    ds_read_b64_tr_b16 v[124:125], v181 offset:36960
    v_mfma_f32_16x16x32_bf16 v[64:67], v[160:163], v[132:135], v[64:67]
    ds_read_b64_tr_b16 v[126:127], v181 offset:38240
    v_mfma_f32_16x16x32_bf16 v[68:71], v[160:163], v[136:139], v[68:71]
    ds_read_b64_tr_b16 v[128:129], v180 offset:36992
    v_mfma_f32_16x16x32_bf16 v[72:75], v[160:163], v[140:143], v[72:75]
    ds_read_b64_tr_b16 v[130:131], v180 offset:38272
    v_mfma_f32_16x16x32_bf16 v[76:79], v[160:163], v[144:147], v[76:79]
    v_mfma_f32_16x16x32_bf16 v[80:83], v[164:167], v[132:135], v[80:83]
    v_mfma_f32_16x16x32_bf16 v[84:87], v[164:167], v[136:139], v[84:87]
    v_mfma_f32_16x16x32_bf16 v[88:91], v[164:167], v[140:143], v[88:91]
    v_mfma_f32_16x16x32_bf16 v[92:95], v[164:167], v[144:147], v[92:95]
    s_waitcnt lgkmcnt(0)
    v_mfma_f32_16x16x32_bf16 v[16:19], v[112:115], v[96:99], v[16:19]
    v_mfma_f32_16x16x32_bf16 v[20:23], v[112:115], v[100:103], v[20:23]
    ds_read_b128 v[132:135], v177 offset:36864
    v_mfma_f32_16x16x32_bf16 v[24:27], v[112:115], v[104:107], v[24:27]
    ds_read_b64_tr_b16 v[148:149], v180 offset:47104
    v_mfma_f32_16x16x32_bf16 v[28:31], v[112:115], v[108:111], v[28:31]
    ds_read_b64_tr_b16 v[150:151], v180 offset:48384
    v_mfma_f32_16x16x32_bf16 v[32:35], v[116:119], v[96:99], v[32:35]
    ds_read_b128 v[136:139], v177 offset:38912
    v_mfma_f32_16x16x32_bf16 v[36:39], v[116:119], v[100:103], v[36:39]
    ds_read_b64_tr_b16 v[152:153], v181 offset:47136
    v_mfma_f32_16x16x32_bf16 v[40:43], v[116:119], v[104:107], v[40:43]
    ds_read_b64_tr_b16 v[154:155], v181 offset:48416
    v_mfma_f32_16x16x32_bf16 v[44:47], v[116:119], v[108:111], v[44:47]
    ds_read_b128 v[140:143], v177 offset:40960
    v_mfma_f32_16x16x32_bf16 v[48:51], v[120:123], v[96:99], v[48:51]
    ds_read_b64_tr_b16 v[156:157], v180 offset:47168
    v_mfma_f32_16x16x32_bf16 v[52:55], v[120:123], v[100:103], v[52:55]
    ds_read_b64_tr_b16 v[158:159], v180 offset:48448
    v_mfma_f32_16x16x32_bf16 v[56:59], v[120:123], v[104:107], v[56:59]
    ds_read_b128 v[144:147], v177 offset:43008
    v_mfma_f32_16x16x32_bf16 v[60:63], v[120:123], v[108:111], v[60:63]
    ds_read_b64_tr_b16 v[160:161], v181 offset:47200
    v_mfma_f32_16x16x32_bf16 v[64:67], v[124:127], v[96:99], v[64:67]
    ds_read_b64_tr_b16 v[162:163], v181 offset:48480
    v_mfma_f32_16x16x32_bf16 v[68:71], v[124:127], v[100:103], v[68:71]
    ds_read_b64_tr_b16 v[164:165], v180 offset:47232
    v_mfma_f32_16x16x32_bf16 v[72:75], v[124:127], v[104:107], v[72:75]
    ds_read_b64_tr_b16 v[166:167], v180 offset:48512
    v_mfma_f32_16x16x32_bf16 v[76:79], v[124:127], v[108:111], v[76:79]
    v_mfma_f32_16x16x32_bf16 v[80:83], v[128:131], v[96:99], v[80:83]
    v_mfma_f32_16x16x32_bf16 v[84:87], v[128:131], v[100:103], v[84:87]
    v_mfma_f32_16x16x32_bf16 v[88:91], v[128:131], v[104:107], v[88:91]
    v_mfma_f32_16x16x32_bf16 v[92:95], v[128:131], v[108:111], v[92:95]
    s_waitcnt lgkmcnt(0)
    v_mfma_f32_16x16x32_bf16 v[16:19], v[148:151], v[132:135], v[16:19]
    v_mfma_f32_16x16x32_bf16 v[20:23], v[148:151], v[136:139], v[20:23]
    v_mfma_f32_16x16x32_bf16 v[24:27], v[148:151], v[140:143], v[24:27]
    v_mfma_f32_16x16x32_bf16 v[28:31], v[148:151], v[144:147], v[28:31]
    v_mfma_f32_16x16x32_bf16 v[32:35], v[152:155], v[132:135], v[32:35]
    v_mfma_f32_16x16x32_bf16 v[36:39], v[152:155], v[136:139], v[36:39]
    v_mfma_f32_16x16x32_bf16 v[40:43], v[152:155], v[140:143], v[40:43]
    v_mfma_f32_16x16x32_bf16 v[44:47], v[152:155], v[144:147], v[44:47]
    v_mfma_f32_16x16x32_bf16 v[48:51], v[156:159], v[132:135], v[48:51]
    v_mfma_f32_16x16x32_bf16 v[52:55], v[156:159], v[136:139], v[52:55]
    v_mfma_f32_16x16x32_bf16 v[56:59], v[156:159], v[140:143], v[56:59]
    v_mfma_f32_16x16x32_bf16 v[60:63], v[156:159], v[144:147], v[60:63]
    v_mfma_f32_16x16x32_bf16 v[64:67], v[160:163], v[132:135], v[64:67]
    v_mfma_f32_16x16x32_bf16 v[68:71], v[160:163], v[136:139], v[68:71]
    v_mfma_f32_16x16x32_bf16 v[72:75], v[160:163], v[140:143], v[72:75]
    v_mfma_f32_16x16x32_bf16 v[76:79], v[160:163], v[144:147], v[76:79]
    v_mfma_f32_16x16x32_bf16 v[80:83], v[164:167], v[132:135], v[80:83]
    v_mfma_f32_16x16x32_bf16 v[84:87], v[164:167], v[136:139], v[84:87]
    v_mfma_f32_16x16x32_bf16 v[88:91], v[164:167], v[140:143], v[88:91]
    v_mfma_f32_16x16x32_bf16 v[92:95], v[164:167], v[144:147], v[92:95]
    v_min_u32 v182, 3, v1
    v_lshlrev_b32 v182, 7, v182
    buffer_load_dwordx2 v[180:181], v182, s[24:27], s60 offen sc1
    s_lshl_b32 s50, s47, 3
    s_lshr_b32 s51, s44, 1
    s_lshl_b32 s51, s51, 2
    s_add_u32 s50, s50, s51
    s_mul_i32 s50, s50, 20
    s_mul_i32 s51, s48, 5
    s_add_u32 s50, s50, s51
    s_lshl_b32 s50, s50, 10
    s_add_u32 s50, s50, 4194304
    s_and_b32 s51, s44, 1
    s_lshl_b32 s52, s51, 11
    s_add_u32 s52, s52, s50
    s_lshl_b32 s51, s51, 9
    s_add_u32 s51, s51, s50
    s_add_u32 s51, s51, 4096
    v_lshlrev_b32 v3, 3, v1
    s_nop 3
    v_cvt_pk_bf16_f32 v96, v16, v17
    v_cvt_pk_bf16_f32 v97, v18, v19
    v_cvt_pk_bf16_f32 v98, v32, v33
    v_cvt_pk_bf16_f32 v99, v34, v35
    buffer_store_dwordx4 v[96:99], v10, s[24:27], s52 offen offset:0 sc1
    v_cvt_pk_bf16_f32 v100, v48, v49
    v_cvt_pk_bf16_f32 v101, v50, v51
    v_cvt_pk_bf16_f32 v102, v64, v65
    v_cvt_pk_bf16_f32 v103, v66, v67
    buffer_store_dwordx4 v[100:103], v10, s[24:27], s52 offen offset:1024 sc1
    v_cvt_pk_bf16_f32 v104, v80, v81
    v_cvt_pk_bf16_f32 v105, v82, v83
    buffer_store_dwordx2 v[104:105], v3, s[24:27], s51 offen sc1
    s_add_u32 s52, s52, 20480
    s_add_u32 s51, s51, 20480
    v_cvt_pk_bf16_f32 v108, v20, v21
    v_cvt_pk_bf16_f32 v109, v22, v23
    v_cvt_pk_bf16_f32 v110, v36, v37
    v_cvt_pk_bf16_f32 v111, v38, v39
    buffer_store_dwordx4 v[108:111], v10, s[24:27], s52 offen offset:0 sc1
    v_cvt_pk_bf16_f32 v112, v52, v53
    v_cvt_pk_bf16_f32 v113, v54, v55
    v_cvt_pk_bf16_f32 v114, v68, v69
    v_cvt_pk_bf16_f32 v115, v70, v71
    buffer_store_dwordx4 v[112:115], v10, s[24:27], s52 offen offset:1024 sc1
    v_cvt_pk_bf16_f32 v116, v84, v85
    v_cvt_pk_bf16_f32 v117, v86, v87
    buffer_store_dwordx2 v[116:117], v3, s[24:27], s51 offen sc1
    s_add_u32 s52, s52, 20480
    s_add_u32 s51, s51, 20480
    v_cvt_pk_bf16_f32 v120, v24, v25
    v_cvt_pk_bf16_f32 v121, v26, v27
    v_cvt_pk_bf16_f32 v122, v40, v41
    v_cvt_pk_bf16_f32 v123, v42, v43
    buffer_store_dwordx4 v[120:123], v10, s[24:27], s52 offen offset:0 sc1
    v_cvt_pk_bf16_f32 v124, v56, v57
    v_cvt_pk_bf16_f32 v125, v58, v59
    v_cvt_pk_bf16_f32 v126, v72, v73
    v_cvt_pk_bf16_f32 v127, v74, v75
    buffer_store_dwordx4 v[124:127], v10, s[24:27], s52 offen offset:1024 sc1
    v_cvt_pk_bf16_f32 v128, v88, v89
    v_cvt_pk_bf16_f32 v129, v90, v91
    buffer_store_dwordx2 v[128:129], v3, s[24:27], s51 offen sc1
    s_add_u32 s52, s52, 20480
    s_add_u32 s51, s51, 20480
    v_cvt_pk_bf16_f32 v132, v28, v29
    v_cvt_pk_bf16_f32 v133, v30, v31
    v_cvt_pk_bf16_f32 v134, v44, v45
    v_cvt_pk_bf16_f32 v135, v46, v47
    buffer_store_dwordx4 v[132:135], v10, s[24:27], s52 offen offset:0 sc1
    v_cvt_pk_bf16_f32 v136, v60, v61
    v_cvt_pk_bf16_f32 v137, v62, v63
    v_cvt_pk_bf16_f32 v138, v76, v77
    v_cvt_pk_bf16_f32 v139, v78, v79
    buffer_store_dwordx4 v[136:139], v10, s[24:27], s52 offen offset:1024 sc1
    v_cvt_pk_bf16_f32 v140, v92, v93
    v_cvt_pk_bf16_f32 v141, v94, v95
    buffer_store_dwordx2 v[140:141], v3, s[24:27], s51 offen sc1
    s_lshl_b32 s58, s47, 9
    s_lshl_b32 s50, s48, 7
    s_add_u32 s58, s58, s50
    s_add_u32 s58, s58, 0x718000
L_pub:
    s_mov_b32 s11, s58
    s_mov_b32 s47, s81
    s_mov_b32 s48, s49
    s_mov_b32 s28, s16
    s_and_b32 s29, s17, 0xffff
    s_mov_b32 s30, 0x600000
    s_mov_b32 s31, 0x20000
    v_lshlrev_b32 v11, 3, v1
    v_add_u32 v12, 4096, v11
    v_add_u32 v13, 61440, v10
    v_add_u32 v14, 61440, v11
    s_lshl_b32 s55, s47, 3
    s_lshl_b32 s50, s44, 1
    s_add_u32 s55, s55, s50
    s_mul_i32 s55, s55, 20480
    s_add_u32 s55, s55, 4194304
    s_mul_i32 s56, s48, 122880
    s_add_u32 s56, s56, 2097152
    s_mul_i32 s50, s44, 3
    s_add_u32 s50, s50, 0
    s_and_b32 s51, s50, 1
    s_lshr_b32 s50, s50, 1
    s_mul_i32 s50, s50, 20480
    s_lshl_b32 s51, s51, 10
    s_add_u32 s57, s50, s51
    s_mul_i32 s50, s44, 3
    s_add_u32 s50, s50, 1
    s_and_b32 s51, s50, 1
    s_lshr_b32 s50, s50, 1
    s_mul_i32 s50, s50, 20480
    s_lshl_b32 s51, s51, 10
    s_add_u32 s58, s50, s51
    s_mul_i32 s50, s44, 3
    s_add_u32 s50, s50, 2
    s_and_b32 s51, s50, 1
    s_lshr_b32 s50, s50, 1
    s_mul_i32 s50, s50, 20480
    s_lshl_b32 s51, s51, 10
    s_add_u32 s59, s50, s51
    s_waitcnt vmcnt(3)
    v_cmp_ne_u32 vcc, s80, v180
    v_cmp_ne_u32 s[84:85], s62, v181
    s_or_b64 vcc, vcc, s[84:85]
    s_cbranch_vccnz L_slow
    s_add_u32 s50, s55, 0
    buffer_load_dwordx4 a[0:3], v10, s[24:27], s50 offen offset:0 sc1
    s_add_u32 s50, s55, 20480
    buffer_load_dwordx4 a[4:7], v10, s[24:27], s50 offen offset:0 sc1
    s_add_u32 s50, s55, 0
    buffer_load_dwordx4 a[8:11], v10, s[24:27], s50 offen offset:1024 sc1
    s_add_u32 s50, s55, 20480
    buffer_load_dwordx4 a[12:15], v10, s[24:27], s50 offen offset:1024 sc1
    s_add_u32 s50, s55, 0
    buffer_load_dwordx4 a[16:19], v10, s[24:27], s50 offen offset:2048 sc1
    s_add_u32 s50, s55, 20480
    buffer_load_dwordx4 a[20:23], v10, s[24:27], s50 offen offset:2048 sc1
    s_add_u32 s50, s55, 0
    buffer_load_dwordx4 a[24:27], v10, s[24:27], s50 offen offset:3072 sc1
    s_add_u32 s50, s55, 20480
    buffer_load_dwordx4 a[28:31], v10, s[24:27], s50 offen offset:3072 sc1
    s_waitcnt vmcnt(8)
    s_barrier
    s_cmp_lg_u32 s44, 0
    s_cbranch_scc1 L_nf_5
    v_mov_b32 v186, s80
    v_mov_b32 v187, s62
    v_mov_b32 v188, 0
    s_mov_b64 s[84:85], exec
    s_mov_b64 exec, 1
    buffer_store_dwordx2 v[186:187], v188, s[24:27], s11 offen sc1
    s_mov_b64 exec, s[84:85]
L_nf_5:
    s_branch L_merge
L_slow:
    s_waitcnt vmcnt(0) lgkmcnt(0)
    s_barrier
    s_cmp_lg_u32 s44, 0
    s_cbranch_scc1 L_nf_6
    v_mov_b32 v186, s80
    v_mov_b32 v187, s62
    v_mov_b32 v188, 0
    s_mov_b64 s[84:85], exec
    s_mov_b64 exec, 1
    buffer_store_dwordx2 v[186:187], v188, s[24:27], s11 offen sc1
    s_mov_b64 exec, s[84:85]
L_nf_6:
    s_movk_i32 s63, 20000
L_spin_7:
    v_cmp_ne_u32 vcc, s80, v180
    v_cmp_ne_u32 s[84:85], s62, v181
    s_or_b64 vcc, vcc, s[84:85]
    s_cbranch_vccz L_ok_8
    s_sub_u32 s63, s63, 1
    s_cmp_eq_u32 s63, 0
    s_cbranch_scc1 L_ok_8
    buffer_load_dwordx2 v[180:181], v182, s[24:27], s60 offen sc1
    s_waitcnt vmcnt(0)
    s_branch L_spin_7
L_ok_8:
    s_add_u32 s50, s55, 0
    buffer_load_dwordx4 a[0:3], v10, s[24:27], s50 offen offset:0 sc1
    s_add_u32 s50, s55, 20480
    buffer_load_dwordx4 a[4:7], v10, s[24:27], s50 offen offset:0 sc1
    s_add_u32 s50, s55, 0
    buffer_load_dwordx4 a[8:11], v10, s[24:27], s50 offen offset:1024 sc1
    s_add_u32 s50, s55, 20480
    buffer_load_dwordx4 a[12:15], v10, s[24:27], s50 offen offset:1024 sc1
    s_add_u32 s50, s55, 0
    buffer_load_dwordx4 a[16:19], v10, s[24:27], s50 offen offset:2048 sc1
    s_add_u32 s50, s55, 20480
    buffer_load_dwordx4 a[20:23], v10, s[24:27], s50 offen offset:2048 sc1
    s_add_u32 s50, s55, 0
    buffer_load_dwordx4 a[24:27], v10, s[24:27], s50 offen offset:3072 sc1
    s_add_u32 s50, s55, 20480
    buffer_load_dwordx4 a[28:31], v10, s[24:27], s50 offen offset:3072 sc1
L_merge:
    s_add_u32 s50, s55, 0
    buffer_load_dwordx2 a[32:33], v12, s[24:27], s50 offen offset:0 sc1
    buffer_load_dwordx2 a[34:35], v12, s[24:27], s50 offen offset:512 sc1
    s_add_u32 s50, s55, 20480
    buffer_load_dwordx2 a[36:37], v12, s[24:27], s50 offen offset:0 sc1
    buffer_load_dwordx2 a[38:39], v12, s[24:27], s50 offen offset:512 sc1
    s_add_u32 s50, s55, 5120
    buffer_load_dwordx4 a[40:43], v10, s[24:27], s50 offen offset:0 sc1
    s_add_u32 s50, s55, 25600
    buffer_load_dwordx4 a[44:47], v10, s[24:27], s50 offen offset:0 sc1
    s_add_u32 s50, s55, 5120
    buffer_load_dwordx4 a[48:51], v10, s[24:27], s50 offen offset:1024 sc1
    s_add_u32 s50, s55, 25600
    buffer_load_dwordx4 a[52:55], v10, s[24:27], s50 offen offset:1024 sc1
    s_add_u32 s50, s55, 5120
    buffer_load_dwordx4 a[56:59], v10, s[24:27], s50 offen offset:2048 sc1
    s_add_u32 s50, s55, 25600
    buffer_load_dwordx4 a[60:63], v10, s[24:27], s50 offen offset:2048 sc1
    s_add_u32 s50, s55, 5120
    buffer_load_dwordx4 a[64:67], v10, s[24:27], s50 offen offset:3072 sc1
    s_add_u32 s50, s55, 25600
    buffer_load_dwordx4 a[68:71], v10, s[24:27], s50 offen offset:3072 sc1
    s_add_u32 s50, s55, 5120
    buffer_load_dwordx2 a[72:73], v12, s[24:27], s50 offen offset:0 sc1
    buffer_load_dwordx2 a[74:75], v12, s[24:27], s50 offen offset:512 sc1
    s_add_u32 s50, s55, 25600
    buffer_load_dwordx2 a[76:77], v12, s[24:27], s50 offen offset:0 sc1
    buffer_load_dwordx2 a[78:79], v12, s[24:27], s50 offen offset:512 sc1
    s_or_b32 s54, s2, s44
    v_min_u32 v182, 15, v1
    v_lshlrev_b32 v182, 7, v182
    buffer_load_dwordx2 v[180:181], v182, s[24:27], s61 offen sc1
    s_waitcnt vmcnt(0)
    s_movk_i32 s63, 20000
L_spin_9:
    v_cmp_ne_u32 vcc, s80, v180
    v_cmp_ne_u32 s[84:85], s62, v181
    s_or_b64 vcc, vcc, s[84:85]
    s_cbranch_vccz L_ok_10
    s_sub_u32 s63, s63, 1
    s_cmp_eq_u32 s63, 0
    s_cbranch_scc1 L_ok_10
    buffer_load_dwordx2 v[180:181], v182, s[24:27], s61 offen sc1
    s_waitcnt vmcnt(0)
    s_branch L_spin_9
L_ok_10:
    s_cmp_lg_u32 s54, 0
    s_cbranch_scc1 L_e1_11
    s_mov_b32 s60, 0x718000
    v_min_u32 v182, 63, v1
    v_lshlrev_b32 v182, 7, v182
    buffer_load_dwordx2 v[180:181], v182, s[24:27], s60 offen sc1
L_e1_11:
    s_add_u32 m0, s57, 0
    s_add_u32 s50, s56, m0
    buffer_load_dwordx4 v10, s[24:27], s50 offen sc1 lds
    s_add_u32 m0, s58, 0
    s_add_u32 s50, s56, m0
    buffer_load_dwordx4 v10, s[24:27], s50 offen sc1 lds
    s_add_u32 m0, s59, 0
    s_add_u32 s50, s56, m0
    buffer_load_dwordx4 v10, s[24:27], s50 offen sc1 lds
    s_add_u32 m0, s57, 2048
    s_add_u32 s50, s56, m0
    buffer_load_dwordx4 v10, s[24:27], s50 offen sc1 lds
    s_add_u32 m0, s58, 2048
    s_add_u32 s50, s56, m0
    buffer_load_dwordx4 v10, s[24:27], s50 offen sc1 lds
    s_add_u32 m0, s59, 2048
    s_add_u32 s50, s56, m0
    buffer_load_dwordx4 v10, s[24:27], s50 offen sc1 lds
    v_and_b32 v2, 15, v1
    v_lshrrev_b32 v3, 4, v1
    s_movk_i32 s52, 3072
    v_mul_u32_u24 v2, s52, v2
    v_lshl_add_u32 v2, v3, 4, v2
    s_lshl_b32 s52, s47, 2
    s_add_u32 s52, s52, s44
    s_mul_i32 s52, s52, 98304
    s_mul_i32 s53, s48, 192
    s_add_u32 s52, s52, s53
    s_add_u32 s53, s52, 49152
    s_waitcnt vmcnt(3)
    s_barrier
    ds_read_b128 v[64:67], v10 offset:0
    ds_read_b128 v[68:71], v10 offset:20480
    ds_read_b128 v[72:75], v10 offset:40960
    ds_read_b128 v[76:79], v13 offset:0
    ds_read_b128 v[80:83], v13 offset:20480
    ds_read_b128 v[84:87], v13 offset:40960
    s_waitcnt lgkmcnt(0)
    v_mfma_f32_16x16x32_bf16 v[16:19], v[64:67], a[0:3], 0
    v_mfma_f32_16x16x32_bf16 v[20:23], v[64:67], a[4:7], 0
    ds_read_b128 v[88:91], v10 offset:1024
    v_mfma_f32_16x16x32_bf16 v[24:27], v[68:71], a[0:3], 0
    ds_read_b128 v[92:95], v10 offset:21504
    v_mfma_f32_16x16x32_bf16 v[28:31], v[68:71], a[4:7], 0
    ds_read_b128 v[96:99], v10 offset:41984
    s_add_u32 m0, s57, 4096
    s_add_u32 s50, s56, m0
    buffer_load_dwordx4 v10, s[24:27], s50 offen sc1 lds
    v_mfma_f32_16x16x32_bf16 v[32:35], v[72:75], a[0:3], 0
    ds_read_b128 v[100:103], v13 offset:1024
    v_mfma_f32_16x16x32_bf16 v[36:39], v[72:75], a[4:7], 0
    ds_read_b128 v[104:107], v13 offset:21504
    v_mfma_f32_16x16x32_bf16 v[40:43], v[76:79], a[0:3], 0
    ds_read_b128 v[108:111], v13 offset:41984
    v_mfma_f32_16x16x32_bf16 v[44:47], v[76:79], a[4:7], 0
    s_add_u32 m0, s58, 4096
    s_add_u32 s50, s56, m0
    buffer_load_dwordx4 v10, s[24:27], s50 offen sc1 lds
    v_mfma_f32_16x16x32_bf16 v[48:51], v[80:83], a[0:3], 0
    v_mfma_f32_16x16x32_bf16 v[52:55], v[80:83], a[4:7], 0
    v_mfma_f32_16x16x32_bf16 v[56:59], v[84:87], a[0:3], 0
    v_mfma_f32_16x16x32_bf16 v[60:63], v[84:87], a[4:7], 0
    s_add_u32 m0, s59, 4096
    s_add_u32 s50, s56, m0
    buffer_load_dwordx4 v10, s[24:27], s50 offen sc1 lds
    s_waitcnt lgkmcnt(0)
    v_mfma_f32_16x16x32_bf16 v[16:19], v[88:91], a[8:11], v[16:19]
    v_mfma_f32_16x16x32_bf16 v[20:23], v[88:91], a[12:15], v[20:23]
    s_waitcnt vmcnt(3)
    s_barrier
    ds_read_b128 v[64:67], v10 offset:2048
    v_mfma_f32_16x16x32_bf16 v[24:27], v[92:95], a[8:11], v[24:27]
    ds_read_b128 v[68:71], v10 offset:22528
    v_mfma_f32_16x16x32_bf16 v[28:31], v[92:95], a[12:15], v[28:31]
    ds_read_b128 v[72:75], v10 offset:43008
    s_add_u32 m0, s57, 6144
    s_add_u32 s50, s56, m0
    buffer_load_dwordx4 v10, s[24:27], s50 offen sc1 lds
    v_mfma_f32_16x16x32_bf16 v[32:35], v[96:99], a[8:11], v[32:35]
    ds_read_b128 v[76:79], v13 offset:2048
    v_mfma_f32_16x16x32_bf16 v[36:39], v[96:99], a[12:15], v[36:39]
    ds_read_b128 v[80:83], v13 offset:22528
    v_mfma_f32_16x16x32_bf16 v[40:43], v[100:103], a[8:11], v[40:43]
    ds_read_b128 v[84:87], v13 offset:43008
    v_mfma_f32_16x16x32_bf16 v[44:47], v[100:103], a[12:15], v[44:47]
    s_add_u32 m0, s58, 6144
    s_add_u32 s50, s56, m0
    buffer_load_dwordx4 v10, s[24:27], s50 offen sc1 lds
    v_mfma_f32_16x16x32_bf16 v[48:51], v[104:107], a[8:11], v[48:51]
    v_mfma_f32_16x16x32_bf16 v[52:55], v[104:107], a[12:15], v[52:55]
    v_mfma_f32_16x16x32_bf16 v[56:59], v[108:111], a[8:11], v[56:59]
    v_mfma_f32_16x16x32_bf16 v[60:63], v[108:111], a[12:15], v[60:63]
    s_add_u32 m0, s59, 6144
    s_add_u32 s50, s56, m0
    buffer_load_dwordx4 v10, s[24:27], s50 offen sc1 lds
    s_waitcnt lgkmcnt(0)
    v_mfma_f32_16x16x32_bf16 v[16:19], v[64:67], a[16:19], v[16:19]
    v_mfma_f32_16x16x32_bf16 v[20:23], v[64:67], a[20:23], v[20:23]
    ds_read_b128 v[88:91], v10 offset:3072
    v_mfma_f32_16x16x32_bf16 v[24:27], v[68:71], a[16:19], v[24:27]
    ds_read_b128 v[92:95], v10 offset:23552
    v_mfma_f32_16x16x32_bf16 v[28:31], v[68:71], a[20:23], v[28:31]
    ds_read_b128 v[96:99], v10 offset:44032
    s_add_u32 m0, s57, 8192
    s_add_u32 s50, s56, m0
    buffer_load_dwordx4 v10, s[24:27], s50 offen sc1 lds
    v_mfma_f32_16x16x32_bf16 v[32:35], v[72:75], a[16:19], v[32:35]
    ds_read_b128 v[100:103], v13 offset:3072
    v_mfma_f32_16x16x32_bf16 v[36:39], v[72:75], a[20:23], v[36:39]
    ds_read_b128 v[104:107], v13 offset:23552
    v_mfma_f32_16x16x32_bf16 v[40:43], v[76:79], a[16:19], v[40:43]
    ds_read_b128 v[108:111], v13 offset:44032
    v_mfma_f32_16x16x32_bf16 v[44:47], v[76:79], a[20:23], v[44:47]
    s_add_u32 m0, s58, 8192
    s_add_u32 s50, s56, m0
    buffer_load_dwordx4 v10, s[24:27], s50 offen sc1 lds
    v_mfma_f32_16x16x32_bf16 v[48:51], v[80:83], a[16:19], v[48:51]
    s_cmp_lg_u32 s54, 0
    s_cbranch_scc1 L_e2_12
    v_cmp_ne_u32 vcc, s80, v180
    v_cmp_ne_u32 s[84:85], s62, v181
    s_or_b64 vcc, vcc, s[84:85]
    s_cbranch_vccnz L_e2_12
    v_mov_b32 v186, s80
    v_mov_b32 v188, 0
    s_mov_b32 s60, 0x700000
    s_mov_b64 exec, 1
    buffer_store_dword v186, v188, s[24:27], s60 offen sc1
    s_mov_b64 exec, -1
    s_mov_b32 s54, 1
L_e2_12:
    v_mfma_f32_16x16x32_bf16 v[52:55], v[80:83], a[20:23], v[52:55]
    v_mfma_f32_16x16x32_bf16 v[56:59], v[84:87], a[16:19], v[56:59]
    v_mfma_f32_16x16x32_bf16 v[60:63], v[84:87], a[20:23], v[60:63]
    s_add_u32 m0, s59, 8192
    s_add_u32 s50, s56, m0
    buffer_load_dwordx4 v10, s[24:27], s50 offen sc1 lds
    s_waitcnt lgkmcnt(0)
    v_mfma_f32_16x16x32_bf16 v[16:19], v[88:91], a[24:27], v[16:19]
    v_mfma_f32_16x16x32_bf16 v[20:23], v[88:91], a[28:31], v[20:23]
    s_waitcnt vmcnt(6)
    s_barrier
    ds_read_b64 v[64:65], v11 offset:4096
    ds_read_b64 v[66:67], v11 offset:4608
    v_mfma_f32_16x16x32_bf16 v[24:27], v[92:95], a[24:27], v[24:27]
    ds_read_b64 v[68:69], v11 offset:24576
    ds_read_b64 v[70:71], v11 offset:25088
    v_mfma_f32_16x16x32_bf16 v[28:31], v[92:95], a[28:31], v[28:31]
    ds_read_b64 v[72:73], v11 offset:45056
    ds_read_b64 v[74:75], v11 offset:45568
    s_add_u32 m0, s57, 10240
    s_add_u32 s50, s56, m0
    buffer_load_dwordx4 v10, s[24:27], s50 offen sc1 lds
    v_mfma_f32_16x16x32_bf16 v[32:35], v[96:99], a[24:27], v[32:35]
    ds_read_b64 v[76:77], v14 offset:4096
    ds_read_b64 v[78:79], v14 offset:4608
    v_mfma_f32_16x16x32_bf16 v[36:39], v[96:99], a[28:31], v[36:39]
    ds_read_b64 v[80:81], v14 offset:24576
    ds_read_b64 v[82:83], v14 offset:25088
    v_mfma_f32_16x16x32_bf16 v[40:43], v[100:103], a[24:27], v[40:43]
    ds_read_b64 v[84:85], v14 offset:45056
    ds_read_b64 v[86:87], v14 offset:45568
    v_mfma_f32_16x16x32_bf16 v[44:47], v[100:103], a[28:31], v[44:47]
    s_add_u32 m0, s58, 10240
    s_add_u32 s50, s56, m0
    buffer_load_dwordx4 v10, s[24:27], s50 offen sc1 lds
    v_mfma_f32_16x16x32_bf16 v[48:51], v[104:107], a[24:27], v[48:51]
    v_mfma_f32_16x16x32_bf16 v[52:55], v[104:107], a[28:31], v[52:55]
    v_mfma_f32_16x16x32_bf16 v[56:59], v[108:111], a[24:27], v[56:59]
    v_mfma_f32_16x16x32_bf16 v[60:63], v[108:111], a[28:31], v[60:63]
    s_add_u32 m0, s59, 10240
    s_add_u32 s50, s56, m0
    buffer_load_dwordx4 v10, s[24:27], s50 offen sc1 lds
    s_waitcnt lgkmcnt(0)
    v_mfma_f32_16x16x32_bf16 v[16:19], v[64:67], a[32:35], v[16:19]
    v_mfma_f32_16x16x32_bf16 v[20:23], v[64:67], a[36:39], v[20:23]
    ds_read_b128 v[88:91], v10 offset:5120
    v_mfma_f32_16x16x32_bf16 v[24:27], v[68:71], a[32:35], v[24:27]
    ds_read_b128 v[92:95], v10 offset:25600
    v_mfma_f32_16x16x32_bf16 v[28:31], v[68:71], a[36:39], v[28:31]
    ds_read_b128 v[96:99], v10 offset:46080
    s_add_u32 s50, s55, 10240
    buffer_load_dwordx4 a[80:83], v10, s[24:27], s50 offen offset:0 sc1
    v_mfma_f32_16x16x32_bf16 v[32:35], v[72:75], a[32:35], v[32:35]
    ds_read_b128 v[100:103], v13 offset:5120
    v_mfma_f32_16x16x32_bf16 v[36:39], v[72:75], a[36:39], v[36:39]
    ds_read_b128 v[104:107], v13 offset:25600
    v_mfma_f32_16x16x32_bf16 v[40:43], v[76:79], a[32:35], v[40:43]
    ds_read_b128 v[108:111], v13 offset:46080
    v_mfma_f32_16x16x32_bf16 v[44:47], v[76:79], a[36:39], v[44:47]
    s_add_u32 s50, s55, 30720
    buffer_load_dwordx4 a[84:87], v10, s[24:27], s50 offen offset:0 sc1
    v_mfma_f32_16x16x32_bf16 v[48:51], v[80:83], a[32:35], v[48:51]
    v_mfma_f32_16x16x32_bf16 v[52:55], v[80:83], a[36:39], v[52:55]
    v_mfma_f32_16x16x32_bf16 v[56:59], v[84:87], a[32:35], v[56:59]
    v_mfma_f32_16x16x32_bf16 v[60:63], v[84:87], a[36:39], v[60:63]
    s_add_u32 m0, s57, 12288
    s_add_u32 s50, s56, m0
    buffer_load_dwordx4 v10, s[24:27], s50 offen sc1 lds
    s_waitcnt lgkmcnt(0)
    v_mfma_f32_16x16x32_bf16 v[16:19], v[88:91], a[40:43], v[16:19]
    v_mfma_f32_16x16x32_bf16 v[20:23], v[88:91], a[44:47], v[20:23]
    s_waitcnt vmcnt(9)
    s_barrier
    ds_read_b128 v[64:67], v10 offset:6144
    v_mfma_f32_16x16x32_bf16 v[24:27], v[92:95], a[40:43], v[24:27]
    ds_read_b128 v[68:71], v10 offset:26624
    v_mfma_f32_16x16x32_bf16 v[28:31], v[92:95], a[44:47], v[28:31]
    ds_read_b128 v[72:75], v10 offset:47104
    s_add_u32 m0, s58, 12288
    s_add_u32 s50, s56, m0
    buffer_load_dwordx4 v10, s[24:27], s50 offen sc1 lds
    v_mfma_f32_16x16x32_bf16 v[32:35], v[96:99], a[40:43], v[32:35]
    ds_read_b128 v[76:79], v13 offset:6144
    v_mfma_f32_16x16x32_bf16 v[36:39], v[96:99], a[44:47], v[36:39]
    ds_read_b128 v[80:83], v13 offset:26624
    v_mfma_f32_16x16x32_bf16 v[40:43], v[100:103], a[40:43], v[40:43]
    ds_read_b128 v[84:87], v13 offset:47104
    v_mfma_f32_16x16x32_bf16 v[44:47], v[100:103], a[44:47], v[44:47]
    s_add_u32 m0, s59, 12288
    s_add_u32 s50, s56, m0
    buffer_load_dwordx4 v10, s[24:27], s50 offen sc1 lds
    v_mfma_f32_16x16x32_bf16 v[48:51], v[104:107], a[40:43], v[48:51]
    v_mfma_f32_16x16x32_bf16 v[52:55], v[104:107], a[44:47], v[52:55]
    v_mfma_f32_16x16x32_bf16 v[56:59], v[108:111], a[40:43], v[56:59]
    v_mfma_f32_16x16x32_bf16 v[60:63], v[108:111], a[44:47], v[60:63]
    s_add_u32 s50, s55, 10240
    buffer_load_dwordx4 a[88:91], v10, s[24:27], s50 offen offset:1024 sc1
    s_waitcnt lgkmcnt(0)
    v_mfma_f32_16x16x32_bf16 v[16:19], v[64:67], a[48:51], v[16:19]
    v_mfma_f32_16x16x32_bf16 v[20:23], v[64:67], a[52:55], v[20:23]
    ds_read_b128 v[88:91], v10 offset:7168
    v_mfma_f32_16x16x32_bf16 v[24:27], v[68:71], a[48:51], v[24:27]
    ds_read_b128 v[92:95], v10 offset:27648
    v_mfma_f32_16x16x32_bf16 v[28:31], v[68:71], a[52:55], v[28:31]
    ds_read_b128 v[96:99], v10 offset:48128
    s_add_u32 s50, s55, 30720
    buffer_load_dwordx4 a[92:95], v10, s[24:27], s50 offen offset:1024 sc1
    v_mfma_f32_16x16x32_bf16 v[32:35], v[72:75], a[48:51], v[32:35]
    ds_read_b128 v[100:103], v13 offset:7168
    v_mfma_f32_16x16x32_bf16 v[36:39], v[72:75], a[52:55], v[36:39]
    ds_read_b128 v[104:107], v13 offset:27648
    v_mfma_f32_16x16x32_bf16 v[40:43], v[76:79], a[48:51], v[40:43]
    ds_read_b128 v[108:111], v13 offset:48128
    v_mfma_f32_16x16x32_bf16 v[44:47], v[76:79], a[52:55], v[44:47]
    s_add_u32 s50, s55, 10240
    buffer_load_dwordx4 a[96:99], v10, s[24:27], s50 offen offset:2048 sc1
    v_mfma_f32_16x16x32_bf16 v[48:51], v[80:83], a[48:51], v[48:51]
    v_mfma_f32_16x16x32_bf16 v[52:55], v[80:83], a[52:55], v[52:55]
    v_mfma_f32_16x16x32_bf16 v[56:59], v[84:87], a[48:51], v[56:59]
    v_mfma_f32_16x16x32_bf16 v[60:63], v[84:87], a[52:55], v[60:63]
    s_add_u32 s50, s55, 30720
    buffer_load_dwordx4 a[100:103], v10, s[24:27], s50 offen offset:2048 sc1
    s_waitcnt lgkmcnt(0)
    v_mfma_f32_16x16x32_bf16 v[16:19], v[88:91], a[56:59], v[16:19]
    v_mfma_f32_16x16x32_bf16 v[20:23], v[88:91], a[60:63], v[20:23]
    s_waitcnt vmcnt(12)
    s_barrier
    ds_read_b128 v[64:67], v10 offset:8192
    v_mfma_f32_16x16x32_bf16 v[24:27], v[92:95], a[56:59], v[24:27]
    ds_read_b128 v[68:71], v10 offset:28672
    v_mfma_f32_16x16x32_bf16 v[28:31], v[92:95], a[60:63], v[28:31]
    ds_read_b128 v[72:75], v10 offset:49152
    s_add_u32 m0, s57, 14336
    s_add_u32 s50, s56, m0
    buffer_load_dwordx4 v10, s[24:27], s50 offen sc1 lds
    v_mfma_f32_16x16x32_bf16 v[32:35], v[96:99], a[56:59], v[32:35]
    ds_read_b128 v[76:79], v13 offset:8192
    v_mfma_f32_16x16x32_bf16 v[36:39], v[96:99], a[60:63], v[36:39]
    ds_read_b128 v[80:83], v13 offset:28672
    v_mfma_f32_16x16x32_bf16 v[40:43], v[100:103], a[56:59], v[40:43]
    ds_read_b128 v[84:87], v13 offset:49152
    v_mfma_f32_16x16x32_bf16 v[44:47], v[100:103], a[60:63], v[44:47]
    s_add_u32 m0, s58, 14336
    s_add_u32 s50, s56, m0
    buffer_load_dwordx4 v10, s[24:27], s50 offen sc1 lds
    v_mfma_f32_16x16x32_bf16 v[48:51], v[104:107], a[56:59], v[48:51]
    v_mfma_f32_16x16x32_bf16 v[52:55], v[104:107], a[60:63], v[52:55]
    v_mfma_f32_16x16x32_bf16 v[56:59], v[108:111], a[56:59], v[56:59]
    v_mfma_f32_16x16x32_bf16 v[60:63], v[108:111], a[60:63], v[60:63]
    s_add_u32 m0, s59, 14336
    s_add_u32 s50, s56, m0
    buffer_load_dwordx4 v10, s[24:27], s50 offen sc1 lds
    s_waitcnt lgkmcnt(0)
    v_mfma_f32_16x16x32_bf16 v[16:19], v[64:67], a[64:67], v[16:19]
    v_mfma_f32_16x16x32_bf16 v[20:23], v[64:67], a[68:71], v[20:23]
    ds_read_b64 v[88:89], v11 offset:9216
    ds_read_b64 v[90:91], v11 offset:9728
    v_mfma_f32_16x16x32_bf16 v[24:27], v[68:71], a[64:67], v[24:27]
    ds_read_b64 v[92:93], v11 offset:29696
    ds_read_b64 v[94:95], v11 offset:30208
    v_mfma_f32_16x16x32_bf16 v[28:31], v[68:71], a[68:71], v[28:31]
    ds_read_b64 v[96:97], v11 offset:50176
    ds_read_b64 v[98:99], v11 offset:50688
    s_add_u32 s50, s55, 10240
    buffer_load_dwordx4 a[104:107], v10, s[24:27], s50 offen offset:3072 sc1
    v_mfma_f32_16x16x32_bf16 v[32:35], v[72:75], a[64:67], v[32:35]
    ds_read_b64 v[100:101], v14 offset:9216
    ds_read_b64 v[102:103], v14 offset:9728
    v_mfma_f32_16x16x32_bf16 v[36:39], v[72:75], a[68:71], v[36:39]
    ds_read_b64 v[104:105], v14 offset:29696
    ds_read_b64 v[106:107], v14 offset:30208
    v_mfma_f32_16x16x32_bf16 v[40:43], v[76:79], a[64:67], v[40:43]
    ds_read_b64 v[108:109], v14 offset:50176
    ds_read_b64 v[110:111], v14 offset:50688
    v_mfma_f32_16x16x32_bf16 v[44:47], v[76:79], a[68:71], v[44:47]
    s_add_u32 s50, s55, 30720
    buffer_load_dwordx4 a[108:111], v10, s[24:27], s50 offen offset:3072 sc1
    v_mfma_f32_16x16x32_bf16 v[48:51], v[80:83], a[64:67], v[48:51]
    v_mfma_f32_16x16x32_bf16 v[52:55], v[80:83], a[68:71], v[52:55]
    v_mfma_f32_16x16x32_bf16 v[56:59], v[84:87], a[64:67], v[56:59]
    v_mfma_f32_16x16x32_bf16 v[60:63], v[84:87], a[68:71], v[60:63]
    s_add_u32 s50, s55, 10240
    buffer_load_dwordx2 a[112:113], v12, s[24:27], s50 offen offset:0 sc1
    buffer_load_dwordx2 a[114:115], v12, s[24:27], s50 offen offset:512 sc1
    s_waitcnt lgkmcnt(0)
    v_mfma_f32_16x16x32_bf16 v[16:19], v[88:91], a[72:75], v[16:19]
    v_mfma_f32_16x16x32_bf16 v[20:23], v[88:91], a[76:79], v[20:23]
    s_waitcnt vmcnt(16)
    s_barrier
    ds_read_b128 v[64:67], v10 offset:10240
    v_mfma_f32_16x16x32_bf16 v[24:27], v[92:95], a[72:75], v[24:27]
    ds_read_b128 v[68:71], v10 offset:30720
    v_mfma_f32_16x16x32_bf16 v[28:31], v[92:95], a[76:79], v[28:31]
    ds_read_b128 v[72:75], v10 offset:51200
    s_add_u32 s50, s55, 30720
    buffer_load_dwordx2 a[116:117], v12, s[24:27], s50 offen offset:0 sc1
    buffer_load_dwordx2 a[118:119], v12, s[24:27], s50 offen offset:512 sc1
    v_mfma_f32_16x16x32_bf16 v[32:35], v[96:99], a[72:75], v[32:35]
    ds_read_b128 v[76:79], v13 offset:10240
    v_mfma_f32_16x16x32_bf16 v[36:39], v[96:99], a[76:79], v[36:39]
    ds_read_b128 v[80:83], v13 offset:30720
    v_mfma_f32_16x16x32_bf16 v[40:43], v[100:103], a[72:75], v[40:43]
    ds_read_b128 v[84:87], v13 offset:51200
    v_mfma_f32_16x16x32_bf16 v[44:47], v[100:103], a[76:79], v[44:47]
    s_add_u32 m0, s57, 16384
    s_add_u32 s50, s56, m0
    buffer_load_dwordx4 v10, s[24:27], s50 offen sc1 lds
    v_mfma_f32_16x16x32_bf16 v[48:51], v[104:107], a[72:75], v[48:51]
    v_mfma_f32_16x16x32_bf16 v[52:55], v[104:107], a[76:79], v[52:55]
    v_mfma_f32_16x16x32_bf16 v[56:59], v[108:111], a[72:75], v[56:59]
    v_mfma_f32_16x16x32_bf16 v[60:63], v[108:111], a[76:79], v[60:63]
    s_add_u32 m0, s58, 16384
    s_add_u32 s50, s56, m0
    buffer_load_dwordx4 v10, s[24:27], s50 offen sc1 lds
    s_waitcnt vmcnt(18)
    s_waitcnt lgkmcnt(0)
    v_mfma_f32_16x16x32_bf16 v[16:19], v[64:67], a[80:83], v[16:19]
    v_mfma_f32_16x16x32_bf16 v[20:23], v[64:67], a[84:87], v[20:23]
    ds_read_b128 v[88:91], v10 offset:11264
    v_mfma_f32_16x16x32_bf16 v[24:27], v[68:71], a[80:83], v[24:27]
    ds_read_b128 v[92:95], v10 offset:31744
    v_mfma_f32_16x16x32_bf16 v[28:31], v[68:71], a[84:87], v[28:31]
    ds_read_b128 v[96:99], v10 offset:52224
    s_add_u32 m0, s59, 16384
    s_add_u32 s50, s56, m0
    buffer_load_dwordx4 v10, s[24:27], s50 offen sc1 lds
    v_mfma_f32_16x16x32_bf16 v[32:35], v[72:75], a[80:83], v[32:35]
    ds_read_b128 v[100:103], v13 offset:11264
    v_mfma_f32_16x16x32_bf16 v[36:39], v[72:75], a[84:87], v[36:39]
    ds_read_b128 v[104:107], v13 offset:31744
    v_mfma_f32_16x16x32_bf16 v[40:43], v[76:79], a[80:83], v[40:43]
    ds_read_b128 v[108:111], v13 offset:52224
    v_mfma_f32_16x16x32_bf16 v[44:47], v[76:79], a[84:87], v[44:47]
    s_add_u32 s50, s55, 15360
    buffer_load_dwordx4 a[120:123], v10, s[24:27], s50 offen offset:0 sc1
    v_mfma_f32_16x16x32_bf16 v[48:51], v[80:83], a[80:83], v[48:51]
    v_mfma_f32_16x16x32_bf16 v[52:55], v[80:83], a[84:87], v[52:55]
    v_mfma_f32_16x16x32_bf16 v[56:59], v[84:87], a[80:83], v[56:59]
    v_mfma_f32_16x16x32_bf16 v[60:63], v[84:87], a[84:87], v[60:63]
    s_add_u32 s50, s55, 35840
    buffer_load_dwordx4 a[124:127], v10, s[24:27], s50 offen offset:0 sc1
    s_waitcnt vmcnt(16)
    s_waitcnt lgkmcnt(0)
    v_mfma_f32_16x16x32_bf16 v[16:19], v[88:91], a[88:91], v[16:19]
    v_mfma_f32_16x16x32_bf16 v[20:23], v[88:91], a[92:95], v[20:23]
    s_barrier
    ds_read_b128 v[64:67], v10 offset:12288
    v_mfma_f32_16x16x32_bf16 v[24:27], v[92:95], a[88:91], v[24:27]
    ds_read_b128 v[68:71], v10 offset:32768
    v_mfma_f32_16x16x32_bf16 v[28:31], v[92:95], a[92:95], v[28:31]
    ds_read_b128 v[72:75], v10 offset:53248
    s_add_u32 s50, s55, 15360
    buffer_load_dwordx4 a[128:131], v10, s[24:27], s50 offen offset:1024 sc1
    v_mfma_f32_16x16x32_bf16 v[32:35], v[96:99], a[88:91], v[32:35]
    ds_read_b128 v[76:79], v13 offset:12288
    v_mfma_f32_16x16x32_bf16 v[36:39], v[96:99], a[92:95], v[36:39]
    ds_read_b128 v[80:83], v13 offset:32768
    v_mfma_f32_16x16x32_bf16 v[40:43], v[100:103], a[88:91], v[40:43]
    ds_read_b128 v[84:87], v13 offset:53248
    v_mfma_f32_16x16x32_bf16 v[44:47], v[100:103], a[92:95], v[44:47]
    s_add_u32 s50, s55, 35840
    buffer_load_dwordx4 a[132:135], v10, s[24:27], s50 offen offset:1024 sc1
    v_mfma_f32_16x16x32_bf16 v[48:51], v[104:107], a[88:91], v[48:51]
    v_mfma_f32_16x16x32_bf16 v[52:55], v[104:107], a[92:95], v[52:55]
    v_mfma_f32_16x16x32_bf16 v[56:59], v[108:111], a[88:91], v[56:59]
    v_mfma_f32_16x16x32_bf16 v[60:63], v[108:111], a[92:95], v[60:63]
    s_add_u32 m0, s57, 18432
    s_add_u32 s50, s56, m0
    buffer_load_dwordx4 v10, s[24:27], s50 offen sc1 lds
    s_waitcnt vmcnt(17)
    s_waitcnt lgkmcnt(0)
    v_mfma_f32_16x16x32_bf16 v[16:19], v[64:67], a[96:99], v[16:19]
    v_mfma_f32_16x16x32_bf16 v[20:23], v[64:67], a[100:103], v[20:23]
    ds_read_b128 v[88:91], v10 offset:13312
    v_mfma_f32_16x16x32_bf16 v[24:27], v[68:71], a[96:99], v[24:27]
    ds_read_b128 v[92:95], v10 offset:33792
    v_mfma_f32_16x16x32_bf16 v[28:31], v[68:71], a[100:103], v[28:31]
    ds_read_b128 v[96:99], v10 offset:54272
    s_add_u32 m0, s58, 18432
    s_add_u32 s50, s56, m0
    buffer_load_dwordx4 v10, s[24:27], s50 offen sc1 lds
    v_mfma_f32_16x16x32_bf16 v[32:35], v[72:75], a[96:99], v[32:35]
    ds_read_b128 v[100:103], v13 offset:13312
    v_mfma_f32_16x16x32_bf16 v[36:39], v[72:75], a[100:103], v[36:39]
    ds_read_b128 v[104:107], v13 offset:33792
    v_mfma_f32_16x16x32_bf16 v[40:43], v[76:79], a[96:99], v[40:43]
    ds_read_b128 v[108:111], v13 offset:54272
    v_mfma_f32_16x16x32_bf16 v[44:47], v[76:79], a[100:103], v[44:47]
    s_add_u32 m0, s59, 18432
    s_add_u32 s50, s56, m0
    buffer_load_dwordx4 v10, s[24:27], s50 offen sc1 lds
    v_mfma_f32_16x16x32_bf16 v[48:51], v[80:83], a[96:99], v[48:51]
    v_mfma_f32_16x16x32_bf16 v[52:55], v[80:83], a[100:103], v[52:55]
    v_mfma_f32_16x16x32_bf16 v[56:59], v[84:87], a[96:99], v[56:59]
    v_mfma_f32_16x16x32_bf16 v[60:63], v[84:87], a[100:103], v[60:63]
    s_add_u32 s50, s55, 15360
    buffer_load_dwordx4 a[136:139], v10, s[24:27], s50 offen offset:2048 sc1
    s_waitcnt vmcnt(15)
    s_waitcnt lgkmcnt(0)
    v_mfma_f32_16x16x32_bf16 v[16:19], v[88:91], a[104:107], v[16:19]
    v_mfma_f32_16x16x32_bf16 v[20:23], v[88:91], a[108:111], v[20:23]
    s_barrier
    ds_read_b64 v[64:65], v11 offset:14336
    ds_read_b64 v[66:67], v11 offset:14848
    v_mfma_f32_16x16x32_bf16 v[24:27], v[92:95], a[104:107], v[24:27]
    ds_read_b64 v[68:69], v11 offset:34816
    ds_read_b64 v[70:71], v11 offset:35328
    v_mfma_f32_16x16x32_bf16 v[28:31], v[92:95], a[108:111], v[28:31]
    ds_read_b64 v[72:73], v11 offset:55296
    ds_read_b64 v[74:75], v11 offset:55808
    s_add_u32 s50, s55, 35840
    buffer_load_dwordx4 a[140:143], v10, s[24:27], s50 offen offset:2048 sc1
    v_mfma_f32_16x16x32_bf16 v[32:35], v[96:99], a[104:107], v[32:35]
    ds_read_b64 v[76:77], v14 offset:14336
    ds_read_b64 v[78:79], v14 offset:14848
    v_mfma_f32_16x16x32_bf16 v[36:39], v[96:99], a[108:111], v[36:39]
    ds_read_b64 v[80:81], v14 offset:34816
    ds_read_b64 v[82:83], v14 offset:35328
    v_mfma_f32_16x16x32_bf16 v[40:43], v[100:103], a[104:107], v[40:43]
    ds_read_b64 v[84:85], v14 offset:55296
    ds_read_b64 v[86:87], v14 offset:55808
    v_mfma_f32_16x16x32_bf16 v[44:47], v[100:103], a[108:111], v[44:47]
    s_add_u32 s50, s55, 15360
    buffer_load_dwordx4 a[144:147], v10, s[24:27], s50 offen offset:3072 sc1
    v_mfma_f32_16x16x32_bf16 v[48:51], v[104:107], a[104:107], v[48:51]
    v_mfma_f32_16x16x32_bf16 v[52:55], v[104:107], a[108:111], v[52:55]
    v_mfma_f32_16x16x32_bf16 v[56:59], v[108:111], a[104:107], v[56:59]
    v_mfma_f32_16x16x32_bf16 v[60:63], v[108:111], a[108:111], v[60:63]
    s_add_u32 s50, s55, 35840
    buffer_load_dwordx4 a[148:151], v10, s[24:27], s50 offen offset:3072 sc1
    s_waitcnt vmcnt(14)
    s_waitcnt lgkmcnt(0)
    v_mfma_f32_16x16x32_bf16 v[16:19], v[64:67], a[112:115], v[16:19]
    v_mfma_f32_16x16x32_bf16 v[20:23], v[64:67], a[116:119], v[20:23]
    ds_read_b128 v[88:91], v10 offset:15360
    v_mfma_f32_16x16x32_bf16 v[24:27], v[68:71], a[112:115], v[24:27]
    ds_read_b128 v[92:95], v10 offset:35840
    v_mfma_f32_16x16x32_bf16 v[28:31], v[68:71], a[116:119], v[28:31]
    ds_read_b128 v[96:99], v10 offset:56320
    s_add_u32 s50, s55, 15360
    buffer_load_dwordx2 a[152:153], v12, s[24:27], s50 offen offset:0 sc1
    buffer_load_dwordx2 a[154:155], v12, s[24:27], s50 offen offset:512 sc1
    v_mfma_f32_16x16x32_bf16 v[32:35], v[72:75], a[112:115], v[32:35]
    ds_read_b128 v[100:103], v13 offset:15360
    v_mfma_f32_16x16x32_bf16 v[36:39], v[72:75], a[116:119], v[36:39]
    ds_read_b128 v[104:107], v13 offset:35840
    v_mfma_f32_16x16x32_bf16 v[40:43], v[76:79], a[112:115], v[40:43]
    ds_read_b128 v[108:111], v13 offset:56320
    v_mfma_f32_16x16x32_bf16 v[44:47], v[76:79], a[116:119], v[44:47]
    s_add_u32 s50, s55, 35840
    buffer_load_dwordx2 a[156:157], v12, s[24:27], s50 offen offset:0 sc1
    buffer_load_dwordx2 a[158:159], v12, s[24:27], s50 offen offset:512 sc1
    v_mfma_f32_16x16x32_bf16 v[48:51], v[80:83], a[112:115], v[48:51]
    v_mfma_f32_16x16x32_bf16 v[52:55], v[80:83], a[116:119], v[52:55]
    v_mfma_f32_16x16x32_bf16 v[56:59], v[84:87], a[112:115], v[56:59]
    v_mfma_f32_16x16x32_bf16 v[60:63], v[84:87], a[116:119], v[60:63]
    s_waitcnt vmcnt(13)
    s_waitcnt lgkmcnt(0)
    v_mfma_f32_16x16x32_bf16 v[16:19], v[88:91], a[120:123], v[16:19]
    v_mfma_f32_16x16x32_bf16 v[20:23], v[88:91], a[124:127], v[20:23]
    s_barrier
    ds_read_b128 v[64:67], v10 offset:16384
    v_mfma_f32_16x16x32_bf16 v[24:27], v[92:95], a[120:123], v[24:27]
    ds_read_b128 v[68:71], v10 offset:36864
    v_mfma_f32_16x16x32_bf16 v[28:31], v[92:95], a[124:127], v[28:31]
    ds_read_b128 v[72:75], v10 offset:57344
    v_mfma_f32_16x16x32_bf16 v[32:35], v[96:99], a[120:123], v[32:35]
    ds_read_b128 v[76:79], v13 offset:16384
    v_mfma_f32_16x16x32_bf16 v[36:39], v[96:99], a[124:127], v[36:39]
    ds_read_b128 v[80:83], v13 offset:36864
    v_mfma_f32_16x16x32_bf16 v[40:43], v[100:103], a[120:123], v[40:43]
    ds_read_b128 v[84:87], v13 offset:57344
    v_mfma_f32_16x16x32_bf16 v[44:47], v[100:103], a[124:127], v[44:47]
    v_mfma_f32_16x16x32_bf16 v[48:51], v[104:107], a[120:123], v[48:51]
    v_mfma_f32_16x16x32_bf16 v[52:55], v[104:107], a[124:127], v[52:55]
    v_mfma_f32_16x16x32_bf16 v[56:59], v[108:111], a[120:123], v[56:59]
    v_mfma_f32_16x16x32_bf16 v[60:63], v[108:111], a[124:127], v[60:63]
    s_waitcnt vmcnt(11)
    s_waitcnt lgkmcnt(0)
    v_mfma_f32_16x16x32_bf16 v[16:19], v[64:67], a[128:131], v[16:19]
    v_mfma_f32_16x16x32_bf16 v[20:23], v[64:67], a[132:135], v[20:23]
    ds_read_b128 v[88:91], v10 offset:17408
    v_mfma_f32_16x16x32_bf16 v[24:27], v[68:71], a[128:131], v[24:27]
    ds_read_b128 v[92:95], v10 offset:37888
    v_mfma_f32_16x16x32_bf16 v[28:31], v[68:71], a[132:135], v[28:31]
    ds_read_b128 v[96:99], v10 offset:58368
    v_mfma_f32_16x16x32_bf16 v[32:35], v[72:75], a[128:131], v[32:35]
    ds_read_b128 v[100:103], v13 offset:17408
    v_mfma_f32_16x16x32_bf16 v[36:39], v[72:75], a[132:135], v[36:39]
    ds_read_b128 v[104:107], v13 offset:37888
    v_mfma_f32_16x16x32_bf16 v[40:43], v[76:79], a[128:131], v[40:43]
    ds_read_b128 v[108:111], v13 offset:58368
    v_mfma_f32_16x16x32_bf16 v[44:47], v[76:79], a[132:135], v[44:47]
    v_mfma_f32_16x16x32_bf16 v[48:51], v[80:83], a[128:131], v[48:51]
    v_mfma_f32_16x16x32_bf16 v[52:55], v[80:83], a[132:135], v[52:55]
    v_mfma_f32_16x16x32_bf16 v[56:59], v[84:87], a[128:131], v[56:59]
    v_mfma_f32_16x16x32_bf16 v[60:63], v[84:87], a[132:135], v[60:63]
    s_waitcnt vmcnt(6)
    s_waitcnt lgkmcnt(0)
    v_mfma_f32_16x16x32_bf16 v[16:19], v[88:91], a[136:139], v[16:19]
    v_mfma_f32_16x16x32_bf16 v[20:23], v[88:91], a[140:143], v[20:23]
    s_barrier
    ds_read_b128 v[112:115], v10 offset:18432
    v_mfma_f32_16x16x32_bf16 v[24:27], v[92:95], a[136:139], v[24:27]
    ds_read_b128 v[116:119], v10 offset:38912
    v_mfma_f32_16x16x32_bf16 v[28:31], v[92:95], a[140:143], v[28:31]
    ds_read_b64 v[120:121], v11 offset:19456
    ds_read_b64 v[122:123], v11 offset:19968
    v_mfma_f32_16x16x32_bf16 v[32:35], v[96:99], a[136:139], v[32:35]
    ds_read_b64 v[124:125], v11 offset:39936
    ds_read_b64 v[126:127], v11 offset:40448
    v_mfma_f32_16x16x32_bf16 v[36:39], v[96:99], a[140:143], v[36:39]
    v_mfma_f32_16x16x32_bf16 v[40:43], v[100:103], a[136:139], v[40:43]
    v_mfma_f32_16x16x32_bf16 v[44:47], v[100:103], a[140:143], v[44:47]
    v_mfma_f32_16x16x32_bf16 v[48:51], v[104:107], a[136:139], v[48:51]
    v_mfma_f32_16x16x32_bf16 v[52:55], v[104:107], a[140:143], v[52:55]
    v_mfma_f32_16x16x32_bf16 v[56:59], v[108:111], a[136:139], v[56:59]
    v_mfma_f32_16x16x32_bf16 v[60:63], v[108:111], a[140:143], v[60:63]
    s_waitcnt vmcnt(0)
    s_waitcnt lgkmcnt(0)
    v_mfma_f32_16x16x32_bf16 v[16:19], v[112:115], a[144:147], v[16:19]
    ds_read_b128 v[128:131], v10 offset:59392
    v_mfma_f32_16x16x32_bf16 v[20:23], v[112:115], a[148:151], v[20:23]
    v_mfma_f32_16x16x32_bf16 v[24:27], v[116:119], a[144:147], v[24:27]
    ds_read_b128 v[132:135], v13 offset:18432
    v_mfma_f32_16x16x32_bf16 v[28:31], v[116:119], a[148:151], v[28:31]
    v_mfma_f32_16x16x32_bf16 v[16:19], v[120:123], a[152:155], v[16:19]
    ds_read_b64 v[136:137], v11 offset:60416
    ds_read_b64 v[138:139], v11 offset:60928
    v_mfma_f32_16x16x32_bf16 v[20:23], v[120:123], a[156:159], v[20:23]
    v_mfma_f32_16x16x32_bf16 v[24:27], v[124:127], a[152:155], v[24:27]
    ds_read_b64 v[140:141], v14 offset:19456
    ds_read_b64 v[142:143], v14 offset:19968
    v_mfma_f32_16x16x32_bf16 v[28:31], v[124:127], a[156:159], v[28:31]
    s_waitcnt lgkmcnt(0)
    v_mfma_f32_16x16x32_bf16 v[32:35], v[128:131], a[144:147], v[32:35]
    ds_read_b128 v[112:115], v13 offset:38912
    v_mfma_f32_16x16x32_bf16 v[36:39], v[128:131], a[148:151], v[36:39]
    v_mfma_f32_16x16x32_bf16 v[40:43], v[132:135], a[144:147], v[40:43]
    ds_read_b128 v[116:119], v13 offset:59392
    v_cvt_pk_bf16_f32 v96, v16, v17
    v_cvt_pk_bf16_f32 v97, v18, v19
    v_mfma_f32_16x16x32_bf16 v[44:47], v[132:135], a[148:151], v[44:47]
    v_cvt_pk_bf16_f32 v98, v24, v25
    v_cvt_pk_bf16_f32 v99, v26, v27
    v_mfma_f32_16x16x32_bf16 v[32:35], v[136:139], a[152:155], v[32:35]
    ds_read_b64 v[120:121], v14 offset:39936
    ds_read_b64 v[122:123], v14 offset:40448
    buffer_store_dwordx4 v[96:99], v2, s[28:31], s52 offen offset:0 sc0 sc1
    v_mfma_f32_16x16x32_bf16 v[36:39], v[136:139], a[156:159], v[36:39]
    v_cvt_pk_bf16_f32 v100, v20, v21
    v_cvt_pk_bf16_f32 v101, v22, v23
    v_mfma_f32_16x16x32_bf16 v[40:43], v[140:143], a[152:155], v[40:43]
    ds_read_b64 v[124:125], v14 offset:60416
    ds_read_b64 v[126:127], v14 offset:60928
    v_cvt_pk_bf16_f32 v102, v28, v29
    v_cvt_pk_bf16_f32 v103, v30, v31
    v_mfma_f32_16x16x32_bf16 v[44:47], v[140:143], a[156:159], v[44:47]
    buffer_store_dwordx4 v[100:103], v2, s[28:31], s53 offen offset:0 sc0 sc1
    s_waitcnt lgkmcnt(0)
    v_mfma_f32_16x16x32_bf16 v[48:51], v[112:115], a[144:147], v[48:51]
    v_mfma_f32_16x16x32_bf16 v[52:55], v[112:115], a[148:151], v[52:55]
    v_mfma_f32_16x16x32_bf16 v[56:59], v[116:119], a[144:147], v[56:59]
    v_cvt_pk_bf16_f32 v104, v32, v33
    v_cvt_pk_bf16_f32 v105, v34, v35
    v_mfma_f32_16x16x32_bf16 v[60:63], v[116:119], a[148:151], v[60:63]
    v_cvt_pk_bf16_f32 v106, v40, v41
    v_cvt_pk_bf16_f32 v107, v42, v43
    v_mfma_f32_16x16x32_bf16 v[48:51], v[120:123], a[152:155], v[48:51]
    buffer_store_dwordx4 v[104:107], v2, s[28:31], s52 offen offset:64 sc0 sc1
    v_mfma_f32_16x16x32_bf16 v[52:55], v[120:123], a[156:159], v[52:55]
    v_cvt_pk_bf16_f32 v108, v36, v37
    v_cvt_pk_bf16_f32 v109, v38, v39
    v_mfma_f32_16x16x32_bf16 v[56:59], v[124:127], a[152:155], v[56:59]
    v_cvt_pk_bf16_f32 v110, v44, v45
    v_cvt_pk_bf16_f32 v111, v46, v47
    v_mfma_f32_16x16x32_bf16 v[60:63], v[124:127], a[156:159], v[60:63]
    buffer_store_dwordx4 v[108:111], v2, s[28:31], s53 offen offset:64 sc0 sc1
    s_nop 7
    s_nop 3
    v_cvt_pk_bf16_f32 v96, v48, v49
    v_cvt_pk_bf16_f32 v97, v50, v51
    v_cvt_pk_bf16_f32 v98, v56, v57
    v_cvt_pk_bf16_f32 v99, v58, v59
    buffer_store_dwordx4 v[96:99], v2, s[28:31], s52 offen offset:128 sc0 sc1
    v_cvt_pk_bf16_f32 v100, v52, v53
    v_cvt_pk_bf16_f32 v101, v54, v55
    v_cvt_pk_bf16_f32 v102, v60, v61
    v_cvt_pk_bf16_f32 v103, v62, v63
    buffer_store_dwordx4 v[100:103], v2, s[28:31], s53 offen offset:128 sc0 sc1
L_yend:
    s_cmp_lg_u32 s54, 0
    s_cbranch_scc1 L_fin
    s_mov_b32 s60, 0x718000
    v_min_u32 v182, 63, v1
    v_lshlrev_b32 v182, 7, v182
    buffer_load_dwordx2 v[180:181], v182, s[24:27], s60 offen sc1
    s_waitcnt vmcnt(0) lgkmcnt(0)
    s_movk_i32 s63, 20000
L_spin_13:
    v_cmp_ne_u32 vcc, s80, v180
    v_cmp_ne_u32 s[84:85], s62, v181
    s_or_b64 vcc, vcc, s[84:85]
    s_cbranch_vccz L_ok_14
    s_sub_u32 s63, s63, 1
    s_cmp_eq_u32 s63, 0
    s_cbranch_scc1 L_ok_14
    buffer_load_dwordx2 v[180:181], v182, s[24:27], s60 offen sc1
    s_waitcnt vmcnt(0)
    s_branch L_spin_13
L_ok_14:
    v_mov_b32 v186, s80
    v_mov_b32 v188, 0
    s_mov_b32 s60, 0x700000
    s_mov_b64 exec, 1
    buffer_store_dword v186, v188, s[24:27], s60 offen sc1
    s_mov_b64 exec, -1
L_fin:
L_end:
    s_endpgm
.section .rodata,"a"
.p2align 6
.amdhsa_kernel standalone__weight_only_int_quip__prompt_kernel
  .amdhsa_next_free_vgpr 352
  .amdhsa_next_free_sgpr 102
  .amdhsa_accum_offset 192
  .amdhsa_group_segment_fixed_size 0
  .amdhsa_kernarg_size 72
  .amdhsa_user_sgpr_count 2
  .amdhsa_user_sgpr_kernarg_segment_ptr 1
  .amdhsa_system_sgpr_workgroup_id_x 1
.end_amdhsa_kernel
```
